```python
import torch

def _softmax(x, axis=-1):
    return torch.softmax(x, dim=axis)
def _gelu(x):
    return torch.nn.functional.gelu(x, approximate="tanh")
def _silu(x):
    return torch.nn.functional.silu(x)
def _sigmoid(x):
    return torch.sigmoid(x)
def _layernorm(x, axis=-1, eps=1e-5):
    m = x.mean(dim=axis, keepdim=True)
    v = x.var(dim=axis, keepdim=True, unbiased=False)
    return (x - m) / torch.sqrt(v + eps)
def _scatter_add(tgt, idx, src, axis=0):
    return tgt.clone().index_add_(axis, idx, src)
def _segment_sum(src, seg, n):
    out = torch.zeros((n,) + src.shape[1:], dtype=src.dtype)
    return out.index_add_(0, seg, src)
def _pad(x, pw):
    flat = tuple(v for pair in reversed(pw) for v in pair)
    return torch.nn.functional.pad(x, flat)

kernel_name = 'interleave_layers__ssm_conv_h3__mixer_channel_mlp__prompt'

def setup_inputs():

    _w = (lambda a: (lambda t: t.to(torch.bfloat16) if t.is_floating_point() else t)(torch.as_tensor(a)))
    def _A_setup():
        B, S, D = 1, 2048, 448
        ks = 4
        return {
            "q": _w((lambda *s: torch.randn(*s, dtype=torch.bfloat16) * 0.05)(B, S, D)),
            "k": _w((lambda *s: torch.randn(*s, dtype=torch.bfloat16) * 0.4)(B, S, D)),
            "v": _w((lambda *s: torch.randn(*s, dtype=torch.bfloat16) * 0.4)(B, S, D)),
            "shift_k": _w((lambda *s: torch.randn(*s, dtype=torch.bfloat16) * 0.4)(D, ks) * 0.5),
            "ssm_k": _w((lambda *s: torch.randn(*s, dtype=torch.bfloat16) * 0.4)(D, S) * (1.0 / S ** 0.5)),
            "ssm_D": _w((lambda *s: torch.randn(*s, dtype=torch.bfloat16) * 0.4)(D)),
        }
    _A_in = _A_setup()

    def _B_setup():
        B, S, D, F = 1, 2048, 448, 1792
        return {
            "x": _w((lambda *s: torch.randn(*s, dtype=torch.bfloat16) * 0.05)(B, S, D)),
            "w1": _w((lambda *s: torch.randn(*s, dtype=torch.bfloat16) * 0.8)(D, F) * (D ** -0.5)),
            "b1": _w((lambda *s: torch.randn(*s, dtype=torch.bfloat16) * 0.8)(F)),
            "w2": _w((lambda *s: torch.randn(*s, dtype=torch.bfloat16) * 0.8)(F, D) * (F ** -0.5)),
            "b2": _w((lambda *s: torch.randn(*s, dtype=torch.bfloat16) * 0.2)(D)),
        }
    _B_in = _B_setup()

    return {
        "A_q": _A_in["q"],
        "A_k": _A_in["k"],
        "A_v": _A_in["v"],
        "A_shift_k": _A_in["shift_k"],
        "A_ssm_k": _A_in["ssm_k"],
        "A_ssm_D": _A_in["ssm_D"],
        "B_x": _B_in["x"],
        "B_w1": _B_in["w1"],
        "B_b1": _B_in["b1"],
        "B_w2": _B_in["w2"],
        "B_b2": _B_in["b2"],
    }

def reference(A_q, A_k, A_v, A_shift_k, A_ssm_k, A_ssm_D, B_x, B_w1, B_b1, B_w2, B_b2):
    def _A_ref(q, k, v, shift_k, ssm_k, ssm_D):
        B, S, D = q.shape
        ks = shift_k.shape[-1]
        k_pad = _pad(k, ((0, 0), (ks - 1, 0), (0, 0)))
        k_shift = torch.zeros_like(k)
        for t in range(ks):
            k_shift = k_shift + k_pad[:, t:t + S, :] * shift_k[:, ks - 1 - t][None, None, :]
        kv = k_shift * v
        L = 2 * S
        kv_pad = _pad(kv, ((0, 0), (0, S), (0, 0)))
        kf_pad = _pad(ssm_k, ((0, 0), (0, S)))
        kv_f = (lambda x, axes=(-2,-1): torch.fft.rfft2(x.float(), dim=axes))(kv_pad[:, None, :, :], axes=(1, 2))
        kf_f = (lambda x, axes=(-2,-1): torch.fft.rfft2(x.float(), dim=axes))(kf_pad[:, None, :], axes=(1, 2))
        kf_f = (lambda x, *d: x.permute(*d))(kf_f, 1, 2, 0)
        y_f = kv_f * kf_f[None, :, :, :]
        y = (lambda x, s, axes=(-2,-1): torch.fft.irfft2(x, s=s, dim=axes).to(torch.bfloat16))(y_f, (1, L), axes=(1, 2))[:, 0, :S, :]
        y = y + kv * ssm_D[None, None, :]
        return q * y

    def _B_ref(x, w1, b1, w2, b2):
        y = _layernorm(x, axis=-1)
        h = _gelu(torch.einsum("bsd,df->bsf", y, w1) + b1)
        return torch.einsum("bsf,fd->bsd", h, w2) + b2

    x = A_q
    x = x + _A_ref(_layernorm(x, axis=-1), A_k, A_v, A_shift_k, A_ssm_k, A_ssm_D)
    x = x + _B_ref(_layernorm(x, axis=-1), B_w1, B_b1, B_w2, B_b2)
    x = x + _A_ref(_layernorm(x, axis=-1), A_k, A_v, A_shift_k, A_ssm_k, A_ssm_D)
    x = x + _B_ref(_layernorm(x, axis=-1), B_w1, B_b1, B_w2, B_b2)
    return x
```

```asm
; @launch grid=(256,1,1) block=(256,1,1) lds=163840
.amdgcn_target "amdgcn-amd-amdhsa--gfx950"
.text
.globl interleave_layers__ssm_conv_h3__mixer_channel_mlp__prompt_kernel
.p2align 12
  s_endpgm
.p2align 8
.type interleave_layers__ssm_conv_h3__mixer_channel_mlp__prompt_kernel,@function
interleave_layers__ssm_conv_h3__mixer_channel_mlp__prompt_kernel:
  s_cmp_ge_u32 s2, 256
  s_cbranch_scc1 L_end
  s_load_dwordx2 s[12:13], s[0:1], 8
  s_load_dwordx2 s[16:17], s[0:1], 16
  s_load_dwordx2 s[40:41], s[0:1], 24
  s_load_dwordx2 s[32:33], s[0:1], 104
  s_load_dwordx2 s[20:21], s[0:1], 32
  s_load_dwordx2 s[44:45], s[0:1], 40
  s_load_dwordx2 s[8:9], s[0:1], 0
  s_load_dwordx2 s[24:25], s[0:1], 56
  s_load_dwordx2 s[28:29], s[0:1], 72
  s_load_dwordx2 s[48:49], s[0:1], 64
  s_load_dwordx2 s[52:53], s[0:1], 80
  s_load_dwordx2 s[36:37], s[0:1], 88
  v_lshrrev_b32 v2, 6, v0
  v_and_b32 v1, 63, v0
  v_readfirstlane_b32 s3, v2
  s_getpc_b64 s[6:7]
L_here:
  s_lshr_b32 s5, s2, 3
  s_lshl2_add_u32 s5, s5, s3
  s_mul_i32 s5, s5, 384
  v_lshl_add_u32 v4, v1, 7, s5
  v_min_u32 v4, L_end-L_here, v4
  v_mov_b32 v5, s7
  v_add_co_u32 v4, vcc, s6, v4
  v_addc_co_u32 v5, vcc, 0, v5, vcc
  s_mov_b64 exec, 7
  global_load_dword v250, v[4:5], off
  s_mov_b64 exec, -1
  s_mov_b32 s10, 1835008
  s_mov_b32 s11, 0x20000
  s_mov_b64 s[14:15], s[10:11]
  s_mov_b64 s[18:19], s[10:11]
  s_mov_b32 s42, 3584
  s_mov_b32 s43, s11
  s_mov_b64 s[22:23], s[10:11]
  s_mov_b32 s46, 896
  s_mov_b32 s47, s11
  s_mov_b32 s26, 1605632
  s_mov_b32 s27, s11
  s_mov_b64 s[50:51], s[42:43]
  s_mov_b64 s[30:31], s[26:27]
  s_mov_b64 s[54:55], s[46:47]
  s_mov_b64 s[38:39], s[10:11]
  s_mov_b32 s34, 58720256
  s_mov_b32 s35, s11
  s_and_b32 s59, s2, 7
  s_lshr_b32 s60, s2, 3
  s_cmp_eq_u32 s59, 7
  s_cselect_b32 s61, 1073741824, 0
  s_cselect_b32 s59, 0, s59
  s_cmp_eq_u32 s59, 7
  s_cselect_b32 s59, 0, s59
  s_lshl_b32 s58, s59, 5
  s_add_u32 s58, s58, s60
  v_and_b32 v210, 15, v0
  v_bfe_u32 v209, v0, 4, 3
  v_lshrrev_b32 v3, 1, v2
  v_lshl_or_b32 v210, v3, 4, v210
  s_mul_i32 s5, s60, 57344
  s_mul_i32 s6, s59, 128
  s_add_u32 s5, s5, s6
  s_add_u32 s5, s5, s61
  v_mul_u32_u24 v204, 7168, v209
  v_lshlrev_b32 v211, 2, v210
  v_add3_u32 v204, v204, s5, v211
  v_add_u32 v205, 4294966400, v204
  v_add_u32 v206, 4294965504, v204
  v_add_u32 v207, 4294964608, v204
  v_add_u32 v208, 3584, v204
  s_mul_i32 s79, s59, 512
  v_lshlrev_b32 v211, 4, v210
  s_mul_i32 s5, s60, 7168
  s_add_u32 s5, s5, 1079771136
  s_xor_b32 s5, s5, s61
  v_and_b32 v3, 15, v0
  v_lshl_add_u32 v4, v2, 4, v3
  v_lshl_add_u32 v213, v4, 7, s5
  v_lshrrev_b32 v60, 7, v0
  v_and_b32 v61, 127, v0
  s_lshl_b32 s5, s58, 1
  v_add_u32 v62, s5, v60
  v_lshlrev_b32 v63, 12, v62
  v_lshl_add_u32 v63, v61, 5, v63
  v_add_u32 v64, -4, v63
  v_lshlrev_b32 v62, 1, v62
  s_waitcnt lgkmcnt(0)
  buffer_load_dwordx4 v[148:151], v211, s[40:43], s79 offen
  buffer_load_dword v128, v207, s[12:15], 0 offen offset:0
  buffer_load_dword v129, v206, s[12:15], 0 offen offset:0
  buffer_load_dword v130, v205, s[12:15], 0 offen offset:0
  buffer_load_dword v131, v204, s[12:15], 0 offen offset:0
  buffer_load_dword v132, v204, s[12:15], 0 offen offset:896
  buffer_load_dword v133, v204, s[12:15], 0 offen offset:1792
  buffer_load_dword v134, v204, s[12:15], 0 offen offset:2688
  buffer_load_dword v135, v208, s[12:15], 0 offen offset:0
  buffer_load_dword v136, v208, s[12:15], 0 offen offset:896
  buffer_load_dword v137, v208, s[12:15], 0 offen offset:1792
  buffer_load_dword v138, v208, s[12:15], 0 offen offset:2688
  buffer_load_dword v140, v204, s[16:19], 0 offen offset:0
  buffer_load_dword v141, v204, s[16:19], 0 offen offset:896
  buffer_load_dword v142, v204, s[16:19], 0 offen offset:1792
  buffer_load_dword v143, v204, s[16:19], 0 offen offset:2688
  buffer_load_dword v144, v208, s[16:19], 0 offen offset:0
  buffer_load_dword v145, v208, s[16:19], 0 offen offset:896
  buffer_load_dword v146, v208, s[16:19], 0 offen offset:1792
  buffer_load_dword v147, v208, s[16:19], 0 offen offset:2688
  buffer_load_dword v92, off, s[32:35], 0 sc1
  buffer_load_dwordx4 v[42:45], v63, s[20:23], 0 offen
  buffer_load_dwordx4 v[46:49], v63, s[20:23], 0 offen offset:16
  buffer_load_dword v50, v64, s[20:23], 0 offen
  buffer_load_ushort v51, v62, s[44:47], 0 offen
  s_mov_b64 exec, 65535
  buffer_load_dword v213, v213, s[32:35], 0 offen
  s_mov_b64 exec, -1
  s_and_b32 s5, s2, 7
  s_bfe_u32 s57, s2, 0x30003
  s_mul_i32 s80, s5, 14
  s_lshr_b32 s80, s80, 3
  s_and_b32 s75, s5, 3
  s_and_b32 s5, s57, 1
  s_lshl_b32 s62, s5, 5
  s_mul_i32 s84, s3, 3072
  s_mul_i32 s85, s3, 7168
  s_mul_i32 s5, s57, 224
  s_add_u32 s5, s5, s62
  s_mul_i32 s65, s5, 896
  s_add_u32 s65, s65, s85
  s_mul_i32 s73, s75, 43008
  s_add_u32 s73, s73, s65
  v_lshlrev_b32 v118, 4, v1
  v_xor_b32 v120, 64, v118
  v_add_u32 v122, 4096, v118
  v_add_u32 v124, 4096, v120
  v_add_u32 v74, 16, v1
  v_add_u32 v75, 32, v1
  v_add_u32 v76, 48, v1
  v_bitop3_b32 v119, v74, 64, v118 bitop3:0x6a
  v_bitop3_b32 v121, v75, 64, v120 bitop3:0x6a
  v_bitop3_b32 v123, v76, 64, v122 bitop3:0x6a
  s_lshl_b32 s64, s85, 2
  s_lshl1_add_u32 s64, s5, s64
  s_mul_i32 s66, s80, 114688
  s_add_u32 s66, s66, s64
  s_add_u32 s67, s64, 1605632
  s_and_b32 s5, s3, 1
  s_lshl_b32 s5, s5, 6
  s_movk_i32 s6, 3200
  v_xor_b32 v76, s5, v118
  v_mul_u32_u24 v74, 2731, v1
  v_lshrrev_b32 v75, 12, v74
  v_lshrrev_b32 v28, 16, v74
  v_bitop3_b32 v75, v75, 32, v76 bitop3:0x6a
  v_mad_u32_u24 v28, v28, s6, v75
  v_add_u32 v74, 174784, v74
  v_lshrrev_b32 v75, 12, v74
  v_lshrrev_b32 v29, 16, v74
  v_bitop3_b32 v75, v75, 32, v76 bitop3:0x6a
  v_mad_u32_u24 v29, v29, s6, v75
  v_add_u32 v74, 174784, v74
  v_lshrrev_b32 v75, 12, v74
  v_lshrrev_b32 v30, 16, v74
  v_bitop3_b32 v75, v75, 32, v76 bitop3:0x6a
  v_mad_u32_u24 v30, v30, s6, v75
  s_add_u32 s100, s3, 4278190088
  s_mov_b32 s101, 0
  s_nop 0
  s_mov_b64 exec, 0
L_visit:
  s_bitcmp1_b32 s100, 3
  s_cbranch_scc1 L_tree3_0
  s_bitcmp1_b32 s100, 2
  s_cbranch_scc1 L_tree2_0
  s_bitcmp1_b32 s100, 1
  s_cbranch_scc1 L_tree1_0
  s_bitcmp1_b32 s100, 0
  s_cbranch_scc1 L_hop1
  s_branch L_hop0
L_tree1_0:
  s_bitcmp1_b32 s100, 0
  s_cbranch_scc1 L_hop3
  s_branch L_hop2
L_tree2_0:
  s_bitcmp1_b32 s100, 1
  s_cbranch_scc1 L_tree1_4
  s_bitcmp1_b32 s100, 0
  s_cbranch_scc1 L_hop5
  s_branch L_hop4
L_tree1_4:
  s_bitcmp1_b32 s100, 0
  s_cbranch_scc1 L_hop7
  s_branch L_hop6
L_tree3_0:
  s_bitcmp1_b32 s100, 2
  s_cbranch_scc1 L_tree2_8
  s_bitcmp1_b32 s100, 1
  s_cbranch_scc1 L_tree1_8
  s_bitcmp1_b32 s100, 0
  s_cbranch_scc1 L_hop9
  s_branch L_hop8
L_tree1_8:
  s_bitcmp1_b32 s100, 0
  s_cbranch_scc1 L_hop11
  s_branch L_hop10
L_tree2_8:
  s_bitcmp1_b32 s100, 1
  s_cbranch_scc1 L_tree1_12
  s_bitcmp1_b32 s100, 0
  s_cbranch_scc1 L_hop13
  s_branch L_hop12
L_tree1_12:
  s_bitcmp1_b32 s100, 0
  s_cbranch_scc1 L_hop15
  s_branch L_hop14
L_hop4:
L_hop5:
L_hop6:
L_hop7:
L_hop12:
L_hop13:
L_hop14:
L_hop15:
L_hopret:
  s_add_u32 s100, s100, 16777220
  s_cbranch_scc0 L_visit
  s_mov_b64 exec, -1
  s_cmp_eq_u32 s101, 1
  s_cbranch_scc1 L_site1
L_site0:
  s_mov_b32 s71, 0xffff0000
  v_lshlrev_b32 v205, 13, v210
  s_mul_i32 s5, s59, 262144
  s_lshl_b32 s6, s60, 7
  s_sub_u32 s5, s5, s6
  s_add_u32 s5, s5, 151424
  s_add_u32 s5, s5, s61
  v_xor_b32 v206, 7, v209
  v_lshl_add_u32 v205, v206, 4, v205
  s_add_u32 s6, s5, 4096
  s_mov_b32 s7, 0x05040100
  s_mov_b32 s79, 0x07060302
  s_waitcnt vmcnt(23)
  v_perm_b32 v152, v128, v129, s7
  v_perm_b32 v153, v128, v129, s79
  v_dot2_f32_bf16 v172, v152, v149, 0
  v_dot2_f32_bf16 v173, v153, v151, 0
  s_waitcnt vmcnt(22)
  v_perm_b32 v154, v129, v130, s7
  v_perm_b32 v155, v129, v130, s79
  v_dot2_f32_bf16 v174, v154, v149, 0
  v_dot2_f32_bf16 v175, v155, v151, 0
  s_waitcnt vmcnt(21)
  v_perm_b32 v156, v130, v131, s7
  v_perm_b32 v157, v130, v131, s79
  v_dot2_f32_bf16 v176, v156, v149, 0
  v_dot2_f32_bf16 v177, v157, v151, 0
  v_dot2_f32_bf16 v172, v156, v148, v172
  v_dot2_f32_bf16 v173, v157, v150, v173
  s_waitcnt vmcnt(20)
  v_perm_b32 v158, v131, v132, s7
  v_perm_b32 v159, v131, v132, s79
  v_dot2_f32_bf16 v178, v158, v149, 0
  v_dot2_f32_bf16 v179, v159, v151, 0
  v_dot2_f32_bf16 v174, v158, v148, v174
  v_dot2_f32_bf16 v175, v159, v150, v175
  s_waitcnt vmcnt(19)
  v_perm_b32 v160, v132, v133, s7
  v_perm_b32 v161, v132, v133, s79
  v_dot2_f32_bf16 v180, v160, v149, 0
  v_dot2_f32_bf16 v181, v161, v151, 0
  v_dot2_f32_bf16 v176, v160, v148, v176
  v_dot2_f32_bf16 v177, v161, v150, v177
  s_waitcnt vmcnt(18)
  v_perm_b32 v162, v133, v134, s7
  v_perm_b32 v163, v133, v134, s79
  v_dot2_f32_bf16 v182, v162, v149, 0
  v_dot2_f32_bf16 v183, v163, v151, 0
  v_dot2_f32_bf16 v178, v162, v148, v178
  v_dot2_f32_bf16 v179, v163, v150, v179
  s_waitcnt vmcnt(17)
  v_perm_b32 v164, v134, v135, s7
  v_perm_b32 v165, v134, v135, s79
  v_dot2_f32_bf16 v184, v164, v149, 0
  v_dot2_f32_bf16 v185, v165, v151, 0
  v_dot2_f32_bf16 v180, v164, v148, v180
  v_dot2_f32_bf16 v181, v165, v150, v181
  s_waitcnt vmcnt(16)
  v_perm_b32 v166, v135, v136, s7
  v_perm_b32 v167, v135, v136, s79
  v_dot2_f32_bf16 v186, v166, v149, 0
  v_dot2_f32_bf16 v187, v167, v151, 0
  v_dot2_f32_bf16 v182, v166, v148, v182
  v_dot2_f32_bf16 v183, v167, v150, v183
  s_waitcnt vmcnt(15)
  v_perm_b32 v168, v136, v137, s7
  v_perm_b32 v169, v136, v137, s79
  v_dot2_f32_bf16 v184, v168, v148, v184
  v_dot2_f32_bf16 v185, v169, v150, v185
  s_waitcnt vmcnt(14)
  v_perm_b32 v170, v137, v138, s7
  v_perm_b32 v171, v137, v138, s79
  v_dot2_f32_bf16 v186, v170, v148, v186
  v_dot2_f32_bf16 v187, v171, v150, v187
  s_waitcnt vmcnt(13)
  v_lshlrev_b32 v188, 16, v140
  v_and_b32 v189, s71, v140
  s_waitcnt vmcnt(12)
  v_lshlrev_b32 v190, 16, v141
  v_and_b32 v191, s71, v141
  s_waitcnt vmcnt(11)
  v_lshlrev_b32 v192, 16, v142
  v_and_b32 v193, s71, v142
  s_waitcnt vmcnt(10)
  v_lshlrev_b32 v194, 16, v143
  v_and_b32 v195, s71, v143
  s_waitcnt vmcnt(9)
  v_lshlrev_b32 v196, 16, v144
  v_and_b32 v197, s71, v144
  s_waitcnt vmcnt(8)
  v_lshlrev_b32 v198, 16, v145
  v_and_b32 v199, s71, v145
  s_waitcnt vmcnt(7)
  v_lshlrev_b32 v200, 16, v146
  v_and_b32 v201, s71, v146
  s_waitcnt vmcnt(6)
  v_lshlrev_b32 v202, 16, v147
  v_and_b32 v203, s71, v147
  v_pk_mul_f32 v[172:173], v[172:173], v[188:189]
  v_pk_mul_f32 v[174:175], v[174:175], v[190:191]
  v_pk_mul_f32 v[176:177], v[176:177], v[192:193]
  v_pk_mul_f32 v[178:179], v[178:179], v[194:195]
  v_pk_mul_f32 v[180:181], v[180:181], v[196:197]
  v_pk_mul_f32 v[182:183], v[182:183], v[198:199]
  v_pk_mul_f32 v[184:185], v[184:185], v[200:201]
  v_pk_mul_f32 v[186:187], v[186:187], v[202:203]
  v_cvt_pk_bf16_f32 v84, v186, v184
  v_cvt_pk_bf16_f32 v85, v182, v180
  v_cvt_pk_bf16_f32 v86, v178, v176
  v_cvt_pk_bf16_f32 v87, v174, v172
  buffer_store_dwordx4 v[84:87], v205, s[32:35], s5 offen
  v_cvt_pk_bf16_f32 v88, v187, v185
  v_cvt_pk_bf16_f32 v89, v183, v181
  v_cvt_pk_bf16_f32 v90, v179, v177
  v_cvt_pk_bf16_f32 v91, v175, v173
  buffer_store_dwordx4 v[88:91], v205, s[32:35], s6 offen
  v_min_u32 v2, 1, v1
  v_lshlrev_b32 v2, 30, v2
  s_and_b32 s5, s3, 1
  s_lshr_b32 s6, s3, 1
  v_lshrrev_b32 v74, 4, v1
  s_add_u32 m0, s85, 2048
  s_nop 0
  buffer_load_dwordx4 v118, s[28:31], s73 offen offset:0 lds
  v_bfe_u32 v75, v1, 2, 2
  v_and_b32 v77, 3, v1
  v_lshl_add_u32 v74, v74, 3, v75
  v_mul_u32_u24 v74, 384, v74
  v_lshl_add_u32 v74, v77, 3, v74
  v_lshlrev_b32 v75, 2, v1
  buffer_load_dwordx4 v119, s[28:31], s73 offen offset:1024 lds
  v_and_b32 v75, 0x60, v75
  s_add_u32 s7, s3, s75
  s_and_b32 s7, s7, 3
  s_mul_i32 s7, s7, 96
  s_add_u32 s7, s7, 61440
  v_xad_u32 v110, v75, s7, v74
  buffer_load_dwordx4 v120, s[28:31], s73 offen offset:2048 lds
  s_add_u32 s7, s7, 32
  v_xad_u32 v111, v75, s7, v74
  s_add_u32 s7, s7, 32
  v_xad_u32 v112, v75, s7, v74
  v_lshrrev_b32 v74, 2, v1
  buffer_load_dwordx4 v121, s[28:31], s73 offen offset:3072 lds
  s_add_u32 m0, m0, 4096
  v_mul_u32_u24 v74, 896, v74
  v_lshlrev_b32 v75, 3, v1
  v_and_b32 v75, 64, v75
  v_lshl_add_u32 v76, v77, 4, v74
  v_lshl_add_u32 v74, v77, 3, v74
  s_mul_i32 s6, s6, 448
  buffer_load_dwordx4 v122, s[28:31], s73 offen offset:0 lds
  s_add_u32 s6, s6, 2048
  s_lshl_b32 s5, s5, 5
  s_lshl3_add_u32 s7, s5, s6
  v_xad_u32 v113, v75, s7, v76
  s_add_u32 s7, s7, 64
  v_xad_u32 v114, v75, s7, v76
  buffer_load_dwordx4 v123, s[28:31], s73 offen offset:1024 lds
  s_add_u32 s7, s7, 64
  v_xad_u32 v115, v75, s7, v76
  s_add_u32 s6, s6, s5
  s_add_u32 s6, s6, 192
  v_xad_u32 v116, v75, s6, v74
  buffer_load_dwordx4 v124, s[28:31], s73 offen offset:2048 lds
  s_waitcnt vmcnt(14)
  v_readfirstlane_b32 s4, v92
  s_lshl2_add_u32 s79, s59, s3
  s_lshl_b32 s79, s79, 7
  s_mul_i32 s4, s4, 0x9E3779B1
  s_add_u32 s4, s4, 0x7F4A7C15
  s_lshl2_add_u32 s79, s60, s79
  s_add_u32 m0, s84, 61440
  s_nop 0
  buffer_load_dwordx4 v28, s[24:27], s66 offen offset:0 lds
  s_add_u32 s79, s79, 1982464
  s_getreg_b32 s81, hwreg(HW_REG_XCC_ID, 0, 4)
  s_add_u32 s79, s79, s61
  v_mul_u32_u24 v93, 4096, v1
  s_xor_b32 s7, s4, s81
  v_mov_b32 v92, s7
  s_waitcnt vmcnt(8)
  s_mov_b64 exec, 15
  buffer_store_dword v92, v93, s[32:35], s79 offen
  s_mov_b64 exec, -1
  s_lshr_b32 s7, s2, 3
  s_and_b32 s5, s7, 3
  s_bfe_u32 s7, s7, 0x10004
  s_lshl1_add_u32 s60, s59, s7
  s_lshl4_add_u32 s60, s5, s60
  buffer_load_dwordx4 v29, s[24:27], s66 offen offset:1024 lds
  s_lshl_b32 s60, s60, 8
  s_add_u32 s60, s60, 1982464
  s_add_u32 s60, s60, s61
  s_lshr_b32 s6, s3, 1
  s_and_b32 s5, s3, 1
  buffer_load_dwordx4 v30, s[24:27], s66 offen offset:2048 lds
  s_add_u32 s66, s66, 114688
  s_cmp_eq_u32 s66, s67
  s_cselect_b32 s66, s64, s66
  s_lshl_b32 s5, s5, 11
  s_lshl1_add_u32 s78, s58, s6
  s_lshl_b32 s78, s78, 12
  s_add_u32 s78, s78, s5
  s_add_u32 s78, s78, s61
  s_add_u32 m0, s84, 73728
  s_nop 0
  buffer_load_dwordx4 v28, s[24:27], s66 offen offset:0 lds
  s_add_u32 s78, s78, 147456
  s_mul_i32 s59, s6, 4576
  s_add_u32 s59, s59, s5
  s_add_u32 s59, s59, 47376
  v_cmp_eq_u32 vcc, 0, v61
  v_lshlrev_b32 v51, 16, v51
  buffer_load_dwordx4 v29, s[24:27], s66 offen offset:1024 lds
  v_lshlrev_b32 v52, 16, v42
  v_add_f32 v52, v52, v51
  v_cvt_pk_bf16_f32 v52, v52, v52
  v_bfi_b32 v52, s71, v42, v52
  v_cndmask_b32 v42, v42, v52, vcc
  buffer_load_dwordx4 v30, s[24:27], s66 offen offset:2048 lds
  s_add_u32 s66, s66, 114688
  s_cmp_eq_u32 s66, s67
  s_cselect_b32 s66, s64, s66
  v_cndmask_b32_e64 v50, v50, 0, vcc
  v_mul_u32_u24 v60, 8320, v60
  v_lshl_add_u32 v60, v61, 5, v60
  v_alignbit_b32 v52, v42, v50, 16
  v_alignbit_b32 v53, v43, v42, 16
  s_add_u32 m0, s84, 86016
  s_nop 0
  buffer_load_dwordx4 v28, s[24:27], s66 offen offset:0 lds
  v_alignbit_b32 v54, v44, v43, 16
  v_alignbit_b32 v55, v45, v44, 16
  v_alignbit_b32 v56, v46, v45, 16
  v_alignbit_b32 v57, v47, v46, 16
  v_alignbit_b32 v58, v48, v47, 16
  buffer_load_dwordx4 v29, s[24:27], s66 offen offset:1024 lds
  v_alignbit_b32 v59, v49, v48, 16
  ds_write_b128 v60, v[52:55] offset:30752
  ds_write_b128 v60, v[56:59] offset:30768
  ds_write_b128 v60, v[42:45] offset:34912
  ds_write_b128 v60, v[46:49] offset:34928
  v_lshrrev_b32 v74, 5, v1
  buffer_load_dwordx4 v30, s[24:27], s66 offen offset:2048 lds
  s_add_u32 s66, s66, 114688
  s_cmp_eq_u32 s66, s67
  s_cselect_b32 s66, s64, s66
  v_mul_u32_u24 v74, 4064, v74
  v_mov_b64 v[80:81], 0
  v_mov_b64 v[82:83], 0
  v_add_u32 v74, v74, v118
  ds_write_b128 v74, v[80:83] offset:51472
  s_add_u32 m0, s84, 98304
  s_nop 0
  buffer_load_dwordx4 v28, s[24:27], s66 offen offset:0 lds
  v_bfe_u32 v74, v1, 1, 2
  v_mul_u32_u24 v74, 4160, v74
  v_and_b32 v75, 16, v118
  v_add_u32 v74, v74, v75
  ds_write_b128 v74, v[80:83] offset:30720
  buffer_load_dwordx4 v29, s[24:27], s66 offen offset:1024 lds
  s_add_u32 s76, s75, 1
  s_and_b32 s76, s76, 3
  s_mul_i32 s76, s76, 43008
  s_add_u32 s76, s76, s65
  s_and_b32 s5, s3, 1
  buffer_load_dwordx4 v30, s[24:27], s66 offen offset:2048 lds
  s_add_u32 s66, s66, 114688
  s_cmp_eq_u32 s66, s67
  s_cselect_b32 s66, s64, s66
  s_lshr_b32 s6, s3, 1
  v_and_b32 v125, 1, v1
  v_mul_u32_u24 v125, 4160, v125
  v_bfe_u32 v126, v1, 1, 3
  v_lshl_add_u32 v125, v126, 2, v125
  v_and_b32 v76, 48, v1
  s_add_u32 m0, s84, 110592
  s_nop 0
  buffer_load_dwordx4 v28, s[24:27], s66 offen offset:0 lds
  s_mul_i32 s7, s6, 8320
  s_lshl_b32 s5, s5, 8
  s_add_u32 s7, s7, s5
  s_add_u32 s7, s7, 30724
  v_add3_u32 v125, v125, s7, v76
  buffer_load_dwordx4 v29, s[24:27], s66 offen offset:1024 lds
  v_add_u32 v126, 1024, v125
  v_add_u32 v127, 2048, v125
  v_add_u32 v109, 3072, v125
  v_and_b32 v74, 15, v1
  v_lshlrev_b32 v75, 5, v74
  buffer_load_dwordx4 v30, s[24:27], s66 offen offset:2048 lds
  s_add_u32 s66, s66, 114688
  s_cmp_eq_u32 s66, s67
  s_cselect_b32 s66, s64, s66
  v_sub_u32 v75, v76, v75
  s_mul_i32 s7, s6, 4576
  s_add_u32 s7, s7, s5
  s_add_u32 s7, s7, 47856
  v_add_u32 v106, s7, v75
  s_add_u32 m0, s84, 122880
  s_nop 0
  buffer_load_dwordx4 v28, s[24:27], s66 offen offset:0 lds
  v_lshl_add_u32 v108, v74, 6, v76
  s_lshl_b32 s5, s3, 11
  s_add_u32 s6, s5, 30720
  v_add_u32 v36, s6, v118
  s_lshl2_add_u32 s6, s5, 30720
  v_add_u32 v37, s6, v118
  buffer_load_dwordx4 v29, s[24:27], s66 offen offset:1024 lds
  v_lshlrev_b32 v107, 2, v1
  s_and_b32 s5, s2, 7
  s_lshr_b32 s6, s2, 6
  s_lshl2_add_u32 s56, s5, s6
  s_lshl3_add_u32 s5, s56, s57
  buffer_load_dwordx4 v30, s[24:27], s66 offen offset:2048 lds
  s_add_u32 s66, s66, 114688
  s_cmp_eq_u32 s66, s67
  s_cselect_b32 s66, s64, s66
  s_mul_i32 s5, s5, 7168
  s_mul_i32 s6, s3, 224
  s_add_u32 s5, s5, s6
  v_and_b32 v74, 3, v1
  v_mul_u32_u24 v16, 1788, v74
  s_add_u32 m0, s84, 135168
  s_nop 0
  buffer_load_dwordx4 v28, s[24:27], s66 offen offset:0 lds
  v_lshl_add_u32 v16, v1, 2, v16
  v_add_u32 v75, 8, v1
  v_lshlrev_b32 v75, 24, v75
  v_and_b32 v75, 1073741824, v75
  v_add3_u32 v16, v16, s5, v75
  s_waitcnt vmcnt(13) lgkmcnt(0)
  s_barrier
  buffer_load_dword v94, v107, s[32:35], s60 offen sc1
  ds_read_b64_tr_b16 a[168:169], v113 offset:0
  ds_read_b64_tr_b16 a[170:171], v113 offset:14336
  ds_read_b64_tr_b16 a[172:173], v113 offset:8
  ds_read_b64_tr_b16 a[174:175], v113 offset:14344
  buffer_load_dwordx4 v29, s[24:27], s66 offen offset:1024 lds
  ds_read_b64_tr_b16 a[176:177], v114 offset:0
  ds_read_b64_tr_b16 a[178:179], v114 offset:14336
  ds_read_b64_tr_b16 a[180:181], v114 offset:8
  ds_read_b64_tr_b16 a[182:183], v114 offset:14344
  buffer_load_dwordx4 v30, s[24:27], s66 offen offset:2048 lds
  s_add_u32 s66, s66, 114688
  s_cmp_eq_u32 s66, s67
  s_cselect_b32 s66, s64, s66
  ds_read_b64_tr_b16 a[184:185], v115 offset:0
  ds_read_b64_tr_b16 a[186:187], v115 offset:14336
  ds_read_b64_tr_b16 a[188:189], v115 offset:8
  ds_read_b64_tr_b16 a[190:191], v115 offset:14344
  ds_read_b64_tr_b16 a[192:193], v116 offset:0
  s_add_u32 m0, s84, 147456
  s_nop 0
  buffer_load_dwordx4 v28, s[24:27], s66 offen offset:0 lds
  ds_read_b64_tr_b16 a[194:195], v116 offset:14336
  ds_read_b64_tr_b16 a[0:1], v110 offset:0
  ds_read_b64_tr_b16 a[2:3], v110 offset:1536
  ds_read_b64_tr_b16 a[4:5], v111 offset:0
  buffer_load_dwordx4 v29, s[24:27], s66 offen offset:1024 lds
  ds_read_b64_tr_b16 a[6:7], v111 offset:1536
  ds_read_b64_tr_b16 a[8:9], v112 offset:0
  ds_read_b64_tr_b16 a[10:11], v112 offset:1536
  ds_read_b64_tr_b16 a[12:13], v110 offset:12288
  buffer_load_dwordx4 v30, s[24:27], s66 offen offset:2048 lds
  s_add_u32 s66, s66, 114688
  s_cmp_eq_u32 s66, s67
  s_cselect_b32 s66, s64, s66
  ds_read_b64_tr_b16 a[14:15], v110 offset:13824
  ds_read_b64_tr_b16 a[16:17], v111 offset:12288
  ds_read_b64_tr_b16 a[18:19], v111 offset:13824
  ds_read_b64_tr_b16 a[20:21], v112 offset:12288
  ds_read_b64_tr_b16 a[22:23], v112 offset:13824
  buffer_load_dwordx4 v[18:21], v16, s[8:11], 0 offen
  buffer_load_dwordx4 v[22:25], v16, s[8:11], 0 offen offset:896
  s_mul_i32 s6, s57, 448
  v_min_u32 v27, 111, v0
  v_lshlrev_b32 v27, 2, v27
  buffer_load_dword v26, v27, s[48:51], s6 offen
  s_waitcnt lgkmcnt(0)
  s_barrier
  s_add_u32 s82, s75, 2
  s_and_b32 s82, s82, 3
  s_mul_i32 s82, s82, 43008
  s_add_u32 s82, s82, s65
  s_mov_b32 s83, 0x3eeff558
  v_and_b32 v74, 48, v118
  v_add_u32 v15, 1024, v74
  v_lshrrev_b32 v74, 5, v1
  v_lshl_add_u32 v14, v74, 6, v15
  s_lshl_b32 s5, s3, 2
  v_add_u32 v14, s5, v14
  s_cmp_eq_u32 s62, 0
  s_cselect_b32 s63, 192, 0
  s_sub_u32 s70, s63, s62
  s_mul_i32 s70, s70, 896
  s_add_u32 s70, s70, s65
  v_lshrrev_b32 v74, 2, v1
  v_mul_u32_u24 v74, 3584, v74
  v_and_b32 v76, 48, v118
  v_bitop3_b32 v75, v1, 32, v76 bitop3:0x6a
  s_mul_i32 s5, s57, 448
  s_lshl1_add_u32 s5, s63, s5
  s_add_u32 s6, s3, s80
  s_mul_i32 s6, s6, 114688
  s_add_u32 s5, s5, s6
  v_add3_u32 v74, v74, s5, v75
  v_add_u32 v75, 4293361664, v74
  v_min_u32 v32, v75, v74
  v_add_u32 v75, 4293820416, v74
  v_add_u32 v76, 458752, v74
  v_min_u32 v33, v75, v76
  v_add_u32 v75, 4294279168, v74
  v_add_u32 v76, 917504, v74
  v_min_u32 v34, v75, v76
  v_add_u32 v75, 4294737920, v74
  v_add_u32 v76, 1376256, v74
  v_min_u32 v35, v75, v76
  ds_read2_b32 v[128:129], v125 offset0:0 offset1:1
  ds_read2_b32 v[130:131], v125 offset0:2 offset1:3
  ds_read2_b32 v[132:133], v125 offset0:128 offset1:129
  ds_read2_b32 v[134:135], v125 offset0:130 offset1:131
  ds_read2_b32 v[136:137], v126 offset0:0 offset1:1
  ds_read2_b32 v[138:139], v126 offset0:2 offset1:3
  ds_read2_b32 v[140:141], v126 offset0:128 offset1:129
  ds_read2_b32 v[142:143], v126 offset0:130 offset1:131
  ds_read2_b32 v[144:145], v127 offset0:0 offset1:1
  ds_read2_b32 v[146:147], v127 offset0:2 offset1:3
  ds_read2_b32 v[148:149], v127 offset0:128 offset1:129
  ds_read2_b32 v[150:151], v127 offset0:130 offset1:131
  ds_read2_b32 v[152:153], v109 offset0:0 offset1:1
  ds_read2_b32 v[154:155], v109 offset0:2 offset1:3
  ds_read2_b32 v[156:157], v109 offset0:128 offset1:129
  ds_read2_b32 v[158:159], v109 offset0:130 offset1:131
  s_waitcnt vmcnt(8)
  v_cmp_ne_u32 vcc, v92, v94
  s_cbranch_vccnz L_strip
L_stripdone:
  s_mov_b32 m0, s59
  s_nop 0
  buffer_load_dwordx4 v118, s[32:35], s78 offen sc1 lds
  buffer_load_dwordx4 v118, s[32:35], s78 offen offset:1024 sc1 lds
  s_lshr_b32 s5, s3, 1
  s_add_u32 s6, s75, s5
  s_and_b32 s6, s6, 3
  s_mul_i32 s5, s5, 14336
  s_sub_u32 s5, s65, s5
  s_add_u32 s5, s5, 28672
  s_mul_i32 s68, s6, 43008
  s_add_u32 s68, s68, s5
  s_xor_b32 s6, s6, 2
  s_mul_i32 s69, s6, 43008
  s_add_u32 s69, s69, s5
  ds_read2_b32 v[160:161], v125 offset0:16 offset1:17
  ds_read2_b32 v[162:163], v125 offset0:18 offset1:19
  s_add_u32 m0, s85, 2048
  s_nop 0
  buffer_load_dwordx4 v118, s[28:31], s76 offen offset:0 lds
  ds_read2_b32 v[164:165], v125 offset0:144 offset1:145
  ds_read2_b32 v[166:167], v125 offset0:146 offset1:147
  buffer_load_dwordx4 v119, s[28:31], s76 offen offset:1024 lds
  ds_read2_b32 v[168:169], v126 offset0:16 offset1:17
  ds_read2_b32 v[170:171], v126 offset0:18 offset1:19
  ds_read2_b32 v[172:173], v126 offset0:144 offset1:145
  buffer_load_dwordx4 v120, s[28:31], s76 offen offset:2048 lds
  ds_read2_b32 v[174:175], v126 offset0:146 offset1:147
  ds_read2_b32 v[176:177], v127 offset0:16 offset1:17
  buffer_load_dwordx4 v121, s[28:31], s76 offen offset:3072 lds
  s_add_u32 m0, m0, 4096
  ds_read2_b32 v[178:179], v127 offset0:18 offset1:19
  ds_read2_b32 v[180:181], v127 offset0:144 offset1:145
  ds_read2_b32 v[182:183], v127 offset0:146 offset1:147
  buffer_load_dwordx4 v122, s[28:31], s76 offen offset:0 lds
  ds_read2_b32 v[184:185], v109 offset0:16 offset1:17
  ds_read2_b32 v[186:187], v109 offset0:18 offset1:19
  buffer_load_dwordx4 v123, s[28:31], s76 offen offset:1024 lds
  ds_read2_b32 v[188:189], v109 offset0:144 offset1:145
  ds_read2_b32 v[190:191], v109 offset0:146 offset1:147
  v_lshlrev_b32 v27, 1, v27
  s_waitcnt vmcnt(8)
  v_lshlrev_b32 v84, 16, v26
  v_and_b32 v85, s71, v26
  v_mul_f32 v84, s83, v84
  v_mul_f32 v85, s83, v85
  ds_write_b64 v27, v[84:85] offset:0
  v_lshlrev_b32 v42, 16, v18
  v_and_b32 v43, s71, v18
  v_lshlrev_b32 v44, 16, v19
  v_and_b32 v45, s71, v19
  v_lshlrev_b32 v46, 16, v20
  v_and_b32 v47, s71, v20
  v_lshlrev_b32 v48, 16, v21
  v_and_b32 v49, s71, v21
  v_lshlrev_b32 v50, 16, v22
  v_and_b32 v51, s71, v22
  v_lshlrev_b32 v52, 16, v23
  v_and_b32 v53, s71, v23
  v_lshlrev_b32 v54, 16, v24
  v_and_b32 v55, s71, v24
  v_lshlrev_b32 v56, 16, v25
  v_and_b32 v57, s71, v25
  v_pk_add_f32 v[58:59], v[42:43], v[44:45]
  v_pk_mul_f32 v[60:61], v[42:43], v[42:43]
  v_pk_add_f32 v[62:63], v[46:47], v[48:49]
  v_pk_mul_f32 v[64:65], v[46:47], v[46:47]
  v_pk_fma_f32 v[60:61], v[44:45], v[44:45], v[60:61]
  v_pk_fma_f32 v[64:65], v[48:49], v[48:49], v[64:65]
  v_pk_add_f32 v[58:59], v[58:59], v[62:63]
  v_pk_add_f32 v[60:61], v[60:61], v[64:65]
  v_add_f32 v58, v58, v59
  v_add_f32 v60, v60, v61
  s_nop 1
  v_permlane32_swap_b32 v58, v60
  v_add_f32 v58, v58, v60
  v_mov_b32 v59, v58
  s_nop 1
  v_permlane16_swap_b32 v58, v59
  v_add_f32 v58, v58, v59
  s_nop 1
  v_add_f32_dpp v58, v58, v58 row_ror:8 row_mask:0xf bank_mask:0xf
  s_nop 1
  v_add_f32_dpp v58, v58, v58 row_ror:4 row_mask:0xf bank_mask:0xf
  ds_write_b32 v14, v58 offset:0
  v_pk_add_f32 v[66:67], v[50:51], v[52:53]
  v_pk_mul_f32 v[68:69], v[50:51], v[50:51]
  v_pk_add_f32 v[70:71], v[54:55], v[56:57]
  v_pk_mul_f32 v[72:73], v[54:55], v[54:55]
  v_pk_fma_f32 v[68:69], v[52:53], v[52:53], v[68:69]
  v_pk_fma_f32 v[72:73], v[56:57], v[56:57], v[72:73]
  v_pk_add_f32 v[66:67], v[66:67], v[70:71]
  v_pk_add_f32 v[68:69], v[68:69], v[72:73]
  v_add_f32 v66, v66, v67
  v_add_f32 v68, v68, v69
  s_nop 1
  v_permlane32_swap_b32 v66, v68
  v_add_f32 v66, v66, v68
  v_mov_b32 v67, v66
  s_nop 1
  v_permlane16_swap_b32 v66, v67
  v_add_f32 v66, v66, v67
  s_nop 1
  v_add_f32_dpp v66, v66, v66 row_ror:8 row_mask:0xf bank_mask:0xf
  s_nop 1
  v_add_f32_dpp v66, v66, v66 row_ror:4 row_mask:0xf bank_mask:0xf
  ds_write_b32 v14, v66 offset:256
  s_lshl_b32 s5, s3, 11
  s_add_u32 s5, s5, 2048
  s_add_u32 s79, s5, 24576
  s_cmp_ge_u32 s3, 2
  s_cselect_b32 s79, 65536, s79
  s_mov_b32 s78, 56320
  s_waitcnt vmcnt(6)
  s_barrier
  ds_read_b128 v[74:77], v106 offset:3584
  ds_read_b128 v[78:81], v106 offset:3072
  ds_read_b128 v[82:85], v106 offset:2560
  ds_read_b128 v[86:89], v106 offset:2048
  ds_read_b128 v[90:93], v106 offset:1536
  ds_read_b128 v[94:97], v106 offset:1024
  ds_read_b128 v[98:101], v106 offset:512
  ds_read_b128 v[102:105], v106 offset:0
  s_waitcnt lgkmcnt(7)
  v_mfma_f32_16x16x32_bf16 v[42:45], v[128:131], v[74:77], 0
  buffer_load_dwordx4 v124, s[28:31], s76 offen offset:2048 lds
  ds_read_b64_tr_b16 a[24:25], v110 offset:24576
  ds_read_b64_tr_b16 a[26:27], v110 offset:26112
  v_mfma_f32_16x16x32_bf16 v[46:49], v[132:135], v[74:77], 0
  ds_read_b64_tr_b16 a[28:29], v111 offset:24576
  v_mfma_f32_16x16x32_bf16 v[50:53], v[136:139], v[74:77], 0
  ds_read_b64_tr_b16 a[30:31], v111 offset:26112
  v_mfma_f32_16x16x32_bf16 v[54:57], v[140:143], v[74:77], 0
  s_add_u32 m0, s84, 61440
  s_nop 0
  buffer_load_dwordx4 v28, s[24:27], s66 offen offset:0 lds
  ds_read_b64_tr_b16 a[32:33], v112 offset:24576
  v_mfma_f32_16x16x32_bf16 v[58:61], v[144:147], v[74:77], 0
  ds_read_b64_tr_b16 a[34:35], v112 offset:26112
  v_mfma_f32_16x16x32_bf16 v[62:65], v[148:151], v[74:77], 0
  ds_read_b64_tr_b16 a[36:37], v110 offset:36864
  v_mfma_f32_16x16x32_bf16 v[66:69], v[152:155], v[74:77], 0
  buffer_load_dwordx4 v29, s[24:27], s66 offen offset:1024 lds
  ds_read_b64_tr_b16 a[38:39], v110 offset:38400
  v_mfma_f32_16x16x32_bf16 v[70:73], v[156:159], v[74:77], 0
  s_waitcnt lgkmcnt(14)
  ds_read_b128 v[74:77], v106 offset:3648
  v_mfma_f32_16x16x32_bf16 v[46:49], v[128:131], v[78:81], v[46:49]
  ds_read_b64_tr_b16 a[40:41], v111 offset:36864
  v_mfma_f32_16x16x32_bf16 v[50:53], v[132:135], v[78:81], v[50:53]
  buffer_load_dwordx4 v30, s[24:27], s66 offen offset:2048 lds
  s_add_u32 s66, s66, 114688
  s_cmp_eq_u32 s66, s67
  s_cselect_b32 s66, s64, s66
  ds_read_b64_tr_b16 a[42:43], v111 offset:38400
  v_mfma_f32_16x16x32_bf16 v[54:57], v[136:139], v[78:81], v[54:57]
  ds_read_b64_tr_b16 a[44:45], v112 offset:36864
  v_mfma_f32_16x16x32_bf16 v[58:61], v[140:143], v[78:81], v[58:61]
  ds_read_b64_tr_b16 a[46:47], v112 offset:38400
  v_mfma_f32_16x16x32_bf16 v[62:65], v[144:147], v[78:81], v[62:65]
  s_add_u32 m0, s84, 73728
  s_nop 0
  buffer_load_dwordx4 v28, s[24:27], s66 offen offset:0 lds
  ds_read_b64_tr_b16 a[48:49], v110 offset:49152
  v_mfma_f32_16x16x32_bf16 v[66:69], v[148:151], v[78:81], v[66:69]
  ds_read_b64_tr_b16 a[50:51], v110 offset:50688
  ds_read_b64_tr_b16 a[52:53], v111 offset:49152
  v_mfma_f32_16x16x32_bf16 v[70:73], v[152:155], v[78:81], v[70:73]
  s_waitcnt lgkmcnt(15)
  ds_read_b128 v[78:81], v106 offset:3136
  v_mfma_f32_16x16x32_bf16 v[50:53], v[128:131], v[82:85], v[50:53]
L_hop10:
  s_cbranch_execz L_hopret
  buffer_load_dwordx4 v29, s[24:27], s66 offen offset:1024 lds
  ds_read_b64_tr_b16 a[54:55], v111 offset:50688
  v_mfma_f32_16x16x32_bf16 v[54:57], v[132:135], v[82:85], v[54:57]
  ds_read_b64_tr_b16 a[56:57], v112 offset:49152
  v_mfma_f32_16x16x32_bf16 v[58:61], v[136:139], v[82:85], v[58:61]
  ds_read_b64_tr_b16 a[58:59], v112 offset:50688
  v_mfma_f32_16x16x32_bf16 v[62:65], v[140:143], v[82:85], v[62:65]
  buffer_load_dwordx4 v30, s[24:27], s66 offen offset:2048 lds
  s_add_u32 s66, s66, 114688
  s_cmp_eq_u32 s66, s67
  s_cselect_b32 s66, s64, s66
  ds_read_b64_tr_b16 a[60:61], v110 offset:61440
  v_mfma_f32_16x16x32_bf16 v[66:69], v[144:147], v[82:85], v[66:69]
  ds_read_b64_tr_b16 a[62:63], v110 offset:62976
  v_mfma_f32_16x16x32_bf16 v[70:73], v[148:151], v[82:85], v[70:73]
  ds_read_b128 v[82:85], v106 offset:2624
  v_mfma_f32_16x16x32_bf16 v[54:57], v[128:131], v[86:89], v[54:57]
  ds_read_b64_tr_b16 a[64:65], v111 offset:61440
  v_mfma_f32_16x16x32_bf16 v[58:61], v[132:135], v[86:89], v[58:61]
  ds_read_b64_tr_b16 a[66:67], v111 offset:62976
  v_mfma_f32_16x16x32_bf16 v[62:65], v[136:139], v[86:89], v[62:65]
  ds_read_b64_tr_b16 a[68:69], v112 offset:61440
  v_mfma_f32_16x16x32_bf16 v[66:69], v[140:143], v[86:89], v[66:69]
  ds_read_b64_tr_b16 a[70:71], v112 offset:62976
  v_mfma_f32_16x16x32_bf16 v[70:73], v[144:147], v[86:89], v[70:73]
  ds_read_b128 v[86:89], v106 offset:2112
  v_mfma_f32_16x16x32_bf16 v[58:61], v[128:131], v[90:93], v[58:61]
  v_mfma_f32_16x16x32_bf16 v[62:65], v[132:135], v[90:93], v[62:65]
  v_mfma_f32_16x16x32_bf16 v[66:69], v[136:139], v[90:93], v[66:69]
  s_waitcnt lgkmcnt(1)
  s_barrier
  s_add_u32 m0, s84, 86016
  s_nop 0
  buffer_load_dwordx4 v28, s[24:27], s66 offen offset:0 lds
  v_add_u32 v110, 73728, v110
  v_add_u32 v111, 73728, v111
  v_add_u32 v112, 73728, v112
  ds_read_b64_tr_b16 a[72:73], v110 offset:0
  ds_read_b64_tr_b16 a[74:75], v110 offset:1536
  v_mfma_f32_16x16x32_bf16 v[70:73], v[140:143], v[90:93], v[70:73]
  ds_read_b128 v[90:93], v106 offset:1600
  v_mfma_f32_16x16x32_bf16 v[62:65], v[128:131], v[94:97], v[62:65]
  ds_read_b64_tr_b16 a[76:77], v111 offset:0
  v_mfma_f32_16x16x32_bf16 v[66:69], v[132:135], v[94:97], v[66:69]
  buffer_load_dwordx4 v29, s[24:27], s66 offen offset:1024 lds
  ds_read_b64_tr_b16 a[78:79], v111 offset:1536
  v_mfma_f32_16x16x32_bf16 v[70:73], v[136:139], v[94:97], v[70:73]
  ds_read_b128 v[94:97], v106 offset:1088
  ds_read2_b32 v[192:193], v125 offset0:32 offset1:33
  v_mfma_f32_16x16x32_bf16 v[66:69], v[128:131], v[98:101], v[66:69]
  ds_read_b64_tr_b16 a[80:81], v112 offset:0
  v_mfma_f32_16x16x32_bf16 v[70:73], v[132:135], v[98:101], v[70:73]
  buffer_load_dwordx4 v30, s[24:27], s66 offen offset:2048 lds
  s_add_u32 s66, s66, 114688
  s_cmp_eq_u32 s66, s67
  s_cselect_b32 s66, s64, s66
  ds_read_b128 v[98:101], v106 offset:576
  v_mfma_f32_16x16x32_bf16 v[70:73], v[128:131], v[102:105], v[70:73]
  ds_read_b128 v[102:105], v106 offset:64
  v_mfma_f32_16x16x32_bf16 v[42:45], v[160:163], v[74:77], v[42:45]
  ds_read_b64_tr_b16 a[82:83], v112 offset:1536
  v_mfma_f32_16x16x32_bf16 v[46:49], v[164:167], v[74:77], v[46:49]
  s_add_u32 m0, s84, 98304
  s_nop 0
  buffer_load_dwordx4 v28, s[24:27], s66 offen offset:0 lds
  ds_read_b64_tr_b16 a[84:85], v110 offset:12288
  ds_read2_b32 v[194:195], v125 offset0:34 offset1:35
  v_mfma_f32_16x16x32_bf16 v[50:53], v[168:171], v[74:77], v[50:53]
  ds_read_b64_tr_b16 a[86:87], v110 offset:13824
  v_mfma_f32_16x16x32_bf16 v[54:57], v[172:175], v[74:77], v[54:57]
  ds_read_b64_tr_b16 a[88:89], v111 offset:12288
  v_mfma_f32_16x16x32_bf16 v[58:61], v[176:179], v[74:77], v[58:61]
  buffer_load_dwordx4 v29, s[24:27], s66 offen offset:1024 lds
  ds_read_b64_tr_b16 a[90:91], v111 offset:13824
  v_mfma_f32_16x16x32_bf16 v[62:65], v[180:183], v[74:77], v[62:65]
  ds_read_b64_tr_b16 a[92:93], v112 offset:12288
  v_mfma_f32_16x16x32_bf16 v[66:69], v[184:187], v[74:77], v[66:69]
  ds_read_b64_tr_b16 a[94:95], v112 offset:13824
  ds_read2_b32 v[196:197], v125 offset0:160 offset1:161
  v_mfma_f32_16x16x32_bf16 v[70:73], v[188:191], v[74:77], v[70:73]
  buffer_load_dwordx4 v30, s[24:27], s66 offen offset:2048 lds
  s_add_u32 s66, s66, 114688
  s_cmp_eq_u32 s66, s67
  s_cselect_b32 s66, s64, s66
  ds_read_b128 v[74:77], v106 offset:3712
  v_mfma_f32_16x16x32_bf16 v[46:49], v[160:163], v[78:81], v[46:49]
  ds_read2_b32 v[198:199], v125 offset0:162 offset1:163
  v_mfma_f32_16x16x32_bf16 v[50:53], v[164:167], v[78:81], v[50:53]
  ds_read2_b32 v[200:201], v126 offset0:32 offset1:33
  v_mfma_f32_16x16x32_bf16 v[54:57], v[168:171], v[78:81], v[54:57]
  s_waitcnt vmcnt(6) lgkmcnt(4)
  s_barrier
  s_add_u32 m0, s84, 110592
  s_nop 0
  buffer_load_dwordx4 v28, s[24:27], s66 offen offset:0 lds
  ds_read_b64_tr_b16 a[196:197], v113 offset:0
  v_mfma_f32_16x16x32_bf16 v[58:61], v[172:175], v[78:81], v[58:61]
  ds_read_b64_tr_b16 a[198:199], v113 offset:14336
  ds_read2_b32 v[202:203], v126 offset0:34 offset1:35
  v_mfma_f32_16x16x32_bf16 v[62:65], v[176:179], v[78:81], v[62:65]
  ds_read2_b32 v[204:205], v126 offset0:160 offset1:161
  v_mfma_f32_16x16x32_bf16 v[66:69], v[180:183], v[78:81], v[66:69]
  buffer_load_dwordx4 v29, s[24:27], s66 offen offset:1024 lds
  ds_read_b64_tr_b16 a[200:201], v113 offset:8
  v_mfma_f32_16x16x32_bf16 v[70:73], v[184:187], v[78:81], v[70:73]
  ds_read_b128 v[78:81], v106 offset:3200
  v_mfma_f32_16x16x32_bf16 v[50:53], v[160:163], v[82:85], v[50:53]
  ds_read2_b32 v[206:207], v126 offset0:162 offset1:163
  v_mfma_f32_16x16x32_bf16 v[54:57], v[164:167], v[82:85], v[54:57]
  buffer_load_dwordx4 v30, s[24:27], s66 offen offset:2048 lds
  s_add_u32 s66, s66, 114688
  s_cmp_eq_u32 s66, s67
  s_cselect_b32 s66, s64, s66
  ds_read_b64_tr_b16 a[202:203], v113 offset:14344
  v_mfma_f32_16x16x32_bf16 v[58:61], v[168:171], v[82:85], v[58:61]
  ds_read_b64_tr_b16 a[204:205], v114 offset:0
  ds_read2_b32 v[208:209], v127 offset0:32 offset1:33
  v_mfma_f32_16x16x32_bf16 v[62:65], v[172:175], v[82:85], v[62:65]
  ds_read2_b32 v[210:211], v127 offset0:34 offset1:35
  v_mfma_f32_16x16x32_bf16 v[66:69], v[176:179], v[82:85], v[66:69]
  s_add_u32 m0, s84, 122880
  s_nop 0
  buffer_load_dwordx4 v28, s[24:27], s66 offen offset:0 lds
  ds_read_b64_tr_b16 a[206:207], v114 offset:14336
  v_mfma_f32_16x16x32_bf16 v[70:73], v[180:183], v[82:85], v[70:73]
  ds_read_b128 v[82:85], v106 offset:2688
  v_mfma_f32_16x16x32_bf16 v[54:57], v[160:163], v[86:89], v[54:57]
  ds_read2_b32 v[212:213], v127 offset0:160 offset1:161
  v_mfma_f32_16x16x32_bf16 v[58:61], v[164:167], v[86:89], v[58:61]
  buffer_load_dwordx4 v29, s[24:27], s66 offen offset:1024 lds
  ds_read_b64_tr_b16 a[208:209], v114 offset:8
  ds_read2_b32 v[214:215], v127 offset0:162 offset1:163
  v_mfma_f32_16x16x32_bf16 v[62:65], v[168:171], v[86:89], v[62:65]
  ds_read_b64_tr_b16 a[210:211], v114 offset:14344
  v_mfma_f32_16x16x32_bf16 v[66:69], v[172:175], v[86:89], v[66:69]
L_hop11:
  s_cbranch_execz L_hopret
  ds_read2_b32 v[216:217], v109 offset0:32 offset1:33
  v_mfma_f32_16x16x32_bf16 v[70:73], v[176:179], v[86:89], v[70:73]
  buffer_load_dwordx4 v30, s[24:27], s66 offen offset:2048 lds
  s_add_u32 s66, s66, 114688
  s_cmp_eq_u32 s66, s67
  s_cselect_b32 s66, s64, s66
  ds_read_b128 v[86:89], v106 offset:2176
  v_mfma_f32_16x16x32_bf16 v[58:61], v[160:163], v[90:93], v[58:61]
  ds_read_b64_tr_b16 a[212:213], v115 offset:0
  v_mfma_f32_16x16x32_bf16 v[62:65], v[164:167], v[90:93], v[62:65]
  ds_read2_b32 v[218:219], v109 offset0:34 offset1:35
  ds_read2_b32 v[220:221], v109 offset0:160 offset1:161
  v_mfma_f32_16x16x32_bf16 v[66:69], v[168:171], v[90:93], v[66:69]
  s_add_u32 m0, s85, 135168
  s_nop 0
  buffer_load_dwordx4 v118, s[28:31], s82 offen offset:0 lds
  ds_read_b64_tr_b16 a[214:215], v115 offset:14336
  v_mfma_f32_16x16x32_bf16 v[70:73], v[172:175], v[90:93], v[70:73]
  ds_read_b128 v[90:93], v106 offset:1664
  v_mfma_f32_16x16x32_bf16 v[62:65], v[160:163], v[94:97], v[62:65]
  ds_read_b64_tr_b16 a[216:217], v115 offset:8
  v_mfma_f32_16x16x32_bf16 v[66:69], v[164:167], v[94:97], v[66:69]
  buffer_load_dwordx4 v119, s[28:31], s82 offen offset:1024 lds
  ds_read2_b32 v[222:223], v109 offset0:162 offset1:163
  v_mfma_f32_16x16x32_bf16 v[70:73], v[168:171], v[94:97], v[70:73]
  ds_read_b128 v[94:97], v106 offset:1152
  ds_read2_b32 v[224:225], v125 offset0:48 offset1:49
  v_mfma_f32_16x16x32_bf16 v[66:69], v[160:163], v[98:101], v[66:69]
  ds_read_b64_tr_b16 a[218:219], v115 offset:14344
  v_mfma_f32_16x16x32_bf16 v[70:73], v[164:167], v[98:101], v[70:73]
  buffer_load_dwordx4 v120, s[28:31], s82 offen offset:2048 lds
  ds_read_b128 v[98:101], v106 offset:640
  v_mfma_f32_16x16x32_bf16 v[70:73], v[160:163], v[102:105], v[70:73]
  s_waitcnt lgkmcnt(15)
  ds_read_b128 v[102:105], v106 offset:128
  v_mfma_f32_16x16x32_bf16 v[42:45], v[192:195], v[74:77], v[42:45]
  ds_read2_b32 v[226:227], v125 offset0:50 offset1:51
  v_mfma_f32_16x16x32_bf16 v[46:49], v[196:199], v[74:77], v[46:49]
  buffer_load_dwordx4 v121, s[28:31], s82 offen offset:3072 lds
  s_add_u32 m0, m0, 4096
  ds_read_b64_tr_b16 a[220:221], v116 offset:0
  v_mfma_f32_16x16x32_bf16 v[50:53], v[200:203], v[74:77], v[50:53]
  ds_read2_b32 v[228:229], v125 offset0:176 offset1:177
  v_mfma_f32_16x16x32_bf16 v[54:57], v[204:207], v[74:77], v[54:57]
  ds_read_b64_tr_b16 a[222:223], v116 offset:14336
  v_mfma_f32_16x16x32_bf16 v[58:61], v[208:211], v[74:77], v[58:61]
  s_waitcnt lgkmcnt(15)
  buffer_load_dwordx4 v122, s[28:31], s82 offen offset:0 lds
  v_add_u32 v110, 4294893568, v110
  v_add_u32 v111, 4294893568, v111
  v_add_u32 v112, 4294893568, v112
  ds_read_b64_tr_b16 a[96:97], v110 offset:0
  v_mfma_f32_16x16x32_bf16 v[62:65], v[212:215], v[74:77], v[62:65]
  s_waitcnt lgkmcnt(15)
  ds_read2_b32 v[230:231], v125 offset0:178 offset1:179
  v_mfma_f32_16x16x32_bf16 v[66:69], v[216:219], v[74:77], v[66:69]
  s_waitcnt lgkmcnt(11)
  ds_read_b64_tr_b16 a[98:99], v110 offset:1536
  v_mfma_f32_16x16x32_bf16 v[70:73], v[220:223], v[74:77], v[70:73]
  buffer_load_dwordx4 v123, s[28:31], s82 offen offset:1024 lds
  ds_read_b128 v[74:77], v106 offset:3776
  v_mfma_f32_16x16x32_bf16 v[46:49], v[192:195], v[78:81], v[46:49]
  ds_read2_b32 v[232:233], v126 offset0:48 offset1:49
  ds_read2_b32 v[234:235], v126 offset0:50 offset1:51
  v_mfma_f32_16x16x32_bf16 v[50:53], v[196:199], v[78:81], v[50:53]
  ds_read_b64_tr_b16 a[100:101], v111 offset:0
  v_mfma_f32_16x16x32_bf16 v[54:57], v[200:203], v[78:81], v[54:57]
  buffer_load_dwordx4 v124, s[28:31], s82 offen offset:2048 lds
  ds_read_b64_tr_b16 a[102:103], v111 offset:1536
  v_mfma_f32_16x16x32_bf16 v[58:61], v[204:207], v[78:81], v[58:61]
  ds_read2_b32 v[236:237], v126 offset0:176 offset1:177
  v_mfma_f32_16x16x32_bf16 v[62:65], v[208:211], v[78:81], v[62:65]
  ds_read_b64_tr_b16 a[104:105], v112 offset:0
  v_mfma_f32_16x16x32_bf16 v[66:69], v[212:215], v[78:81], v[66:69]
  ds_read2_b32 v[238:239], v126 offset0:178 offset1:179
  v_mfma_f32_16x16x32_bf16 v[70:73], v[216:219], v[78:81], v[70:73]
  ds_read_b128 v[78:81], v106 offset:3264
  v_mfma_f32_16x16x32_bf16 v[50:53], v[192:195], v[82:85], v[50:53]
  ds_read_b64_tr_b16 a[106:107], v112 offset:1536
  v_mfma_f32_16x16x32_bf16 v[54:57], v[196:199], v[82:85], v[54:57]
  ds_read_b64_tr_b16 a[108:109], v110 offset:12288
  v_mfma_f32_16x16x32_bf16 v[58:61], v[200:203], v[82:85], v[58:61]
  ds_read2_b32 v[240:241], v127 offset0:48 offset1:49
  v_mfma_f32_16x16x32_bf16 v[62:65], v[204:207], v[82:85], v[62:65]
  ds_read_b64_tr_b16 a[110:111], v110 offset:13824
  v_mfma_f32_16x16x32_bf16 v[66:69], v[208:211], v[82:85], v[66:69]
  ds_read2_b32 v[242:243], v127 offset0:50 offset1:51
  v_mfma_f32_16x16x32_bf16 v[70:73], v[212:215], v[82:85], v[70:73]
  ds_read_b128 v[82:85], v106 offset:2752
  ds_read2_b32 v[244:245], v127 offset0:176 offset1:177
  v_mfma_f32_16x16x32_bf16 v[54:57], v[192:195], v[86:89], v[54:57]
  ds_read_b64_tr_b16 a[112:113], v111 offset:12288
  v_mfma_f32_16x16x32_bf16 v[58:61], v[196:199], v[86:89], v[58:61]
  ds_read_b64_tr_b16 a[114:115], v111 offset:13824
  v_mfma_f32_16x16x32_bf16 v[62:65], v[200:203], v[86:89], v[62:65]
  ds_read2_b32 v[246:247], v127 offset0:178 offset1:179
  v_mfma_f32_16x16x32_bf16 v[66:69], v[204:207], v[86:89], v[66:69]
  ds_read_b64_tr_b16 a[116:117], v112 offset:12288
  v_mfma_f32_16x16x32_bf16 v[70:73], v[208:211], v[86:89], v[70:73]
  ds_read_b128 v[86:89], v106 offset:2240
  v_mfma_f32_16x16x32_bf16 v[58:61], v[192:195], v[90:93], v[58:61]
  ds_read2_b32 v[248:249], v109 offset0:48 offset1:49
  v_mfma_f32_16x16x32_bf16 v[62:65], v[196:199], v[90:93], v[62:65]
  ds_read_b64_tr_b16 a[118:119], v112 offset:13824
  v_mfma_f32_16x16x32_bf16 v[66:69], v[200:203], v[90:93], v[66:69]
  ds_read2_b32 v[250:251], v109 offset0:50 offset1:51
  v_mfma_f32_16x16x32_bf16 v[70:73], v[204:207], v[90:93], v[70:73]
  s_waitcnt lgkmcnt(15)
  ds_read_b128 v[90:93], v106 offset:1728
  v_mfma_f32_16x16x32_bf16 v[62:65], v[192:195], v[94:97], v[62:65]
  ds_read2_b32 v[252:253], v109 offset0:176 offset1:177
  v_mfma_f32_16x16x32_bf16 v[66:69], v[196:199], v[94:97], v[66:69]
  ds_read2_b32 v[254:255], v109 offset0:178 offset1:179
  v_mfma_f32_16x16x32_bf16 v[70:73], v[200:203], v[94:97], v[70:73]
  s_waitcnt vmcnt(7) lgkmcnt(4)
  s_barrier
  s_mov_b32 m0, s5
  s_nop 0
  buffer_load_dwordx4 v32, s[24:27], 0 offen offset:0 lds
  ds_read_b128 v[94:97], v106 offset:1216
  v_mfma_f32_16x16x32_bf16 v[66:69], v[192:195], v[98:101], v[66:69]
  ds_read_b64_tr_b16 a[120:121], v110 offset:24576
  v_mfma_f32_16x16x32_bf16 v[70:73], v[196:199], v[98:101], v[70:73]
  ds_read_b128 v[98:101], v106 offset:704
  v_mfma_f32_16x16x32_bf16 v[70:73], v[192:195], v[102:105], v[70:73]
  buffer_load_dwordx4 v32, s[24:27], s78 offen offset:1024 lds
  s_add_u32 m0, m0, 8192
  ds_read_b128 v[102:105], v106 offset:192
  v_mfma_f32_16x16x32_bf16 v[42:45], v[224:227], v[74:77], v[42:45]
  s_waitcnt lgkmcnt(0)
  s_barrier
  ds_read_b64_tr_b16 a[122:123], v110 offset:26112
  v_mfma_f32_16x16x32_bf16 v[46:49], v[228:231], v[74:77], v[46:49]
  ds_read_b64_tr_b16 a[124:125], v111 offset:24576
  v_mfma_f32_16x16x32_bf16 v[46:49], v[224:227], v[78:81], v[46:49]
L_hop8:
  s_cbranch_execz L_hopret
  buffer_load_dwordx4 v33, s[24:27], 0 offen offset:0 lds
  ds_read_b64_tr_b16 a[126:127], v111 offset:26112
  v_mfma_f32_16x16x32_bf16 v[50:53], v[232:235], v[74:77], v[50:53]
  ds_read_b64_tr_b16 a[128:129], v112 offset:24576
  v_mfma_f32_16x16x32_bf16 v[50:53], v[228:231], v[78:81], v[50:53]
  ds_read_b64_tr_b16 a[130:131], v112 offset:26112
  v_mfma_f32_16x16x32_bf16 v[50:53], v[224:227], v[82:85], v[50:53]
  buffer_load_dwordx4 v33, s[24:27], s78 offen offset:1024 lds
  s_add_u32 m0, m0, 8192
  ds_write_b128 v36, v[42:45] offset:0
  v_mfma_f32_16x16x32_bf16 v[54:57], v[236:239], v[74:77], v[54:57]
  v_mfma_f32_16x16x32_bf16 v[54:57], v[232:235], v[78:81], v[54:57]
  ds_write_b128 v36, v[46:49] offset:1024
  v_mfma_f32_16x16x32_bf16 v[54:57], v[228:231], v[82:85], v[54:57]
  buffer_load_dwordx4 v34, s[24:27], 0 offen offset:0 lds
  ds_read_b64_tr_b16 a[132:133], v110 offset:36864
  v_mfma_f32_16x16x32_bf16 v[54:57], v[224:227], v[86:89], v[54:57]
  ds_read_b64_tr_b16 a[134:135], v110 offset:38400
  v_mfma_f32_16x16x32_bf16 v[58:61], v[240:243], v[74:77], v[58:61]
  ds_write_b128 v36, v[50:53] offset:8192
  v_mfma_f32_16x16x32_bf16 v[58:61], v[236:239], v[78:81], v[58:61]
  buffer_load_dwordx4 v34, s[24:27], s78 offen offset:1024 lds
  s_mov_b32 m0, s79
  ds_read_b64_tr_b16 a[136:137], v111 offset:36864
  v_mfma_f32_16x16x32_bf16 v[58:61], v[232:235], v[82:85], v[58:61]
  ds_read_b64_tr_b16 a[138:139], v111 offset:38400
  v_mfma_f32_16x16x32_bf16 v[58:61], v[228:231], v[86:89], v[58:61]
  ds_read_b64_tr_b16 a[140:141], v112 offset:36864
  v_mfma_f32_16x16x32_bf16 v[58:61], v[224:227], v[90:93], v[58:61]
  buffer_load_dwordx4 v35, s[24:27], 0 offen offset:0 lds
  ds_write_b128 v36, v[54:57] offset:9216
  v_mfma_f32_16x16x32_bf16 v[62:65], v[244:247], v[74:77], v[62:65]
  ds_read_b64_tr_b16 a[142:143], v112 offset:38400
  v_mfma_f32_16x16x32_bf16 v[62:65], v[240:243], v[78:81], v[62:65]
  v_mfma_f32_16x16x32_bf16 v[62:65], v[236:239], v[82:85], v[62:65]
  buffer_load_dwordx4 v35, s[24:27], s78 offen offset:1024 lds
  ds_read_b64_tr_b16 a[144:145], v110 offset:49152
  v_mfma_f32_16x16x32_bf16 v[62:65], v[232:235], v[86:89], v[62:65]
  ds_read_b64_tr_b16 a[146:147], v110 offset:50688
  v_mfma_f32_16x16x32_bf16 v[62:65], v[228:231], v[90:93], v[62:65]
  ds_write_b128 v36, v[58:61] offset:16384
  v_mfma_f32_16x16x32_bf16 v[62:65], v[224:227], v[94:97], v[62:65]
  ds_read_b64_tr_b16 a[148:149], v111 offset:49152
  v_mfma_f32_16x16x32_bf16 v[66:69], v[248:251], v[74:77], v[66:69]
  ds_read_b64_tr_b16 a[150:151], v111 offset:50688
  v_mfma_f32_16x16x32_bf16 v[66:69], v[244:247], v[78:81], v[66:69]
  ds_read_b64_tr_b16 a[152:153], v112 offset:49152
  v_mfma_f32_16x16x32_bf16 v[66:69], v[240:243], v[82:85], v[66:69]
  ds_read_b64_tr_b16 a[154:155], v112 offset:50688
  v_mfma_f32_16x16x32_bf16 v[66:69], v[236:239], v[86:89], v[66:69]
  v_mfma_f32_16x16x32_bf16 v[66:69], v[232:235], v[90:93], v[66:69]
  ds_write_b128 v36, v[62:65] offset:17408
  v_mfma_f32_16x16x32_bf16 v[66:69], v[228:231], v[94:97], v[66:69]
  ds_read_b64_tr_b16 a[156:157], v110 offset:61440
  v_mfma_f32_16x16x32_bf16 v[66:69], v[224:227], v[98:101], v[66:69]
  ds_read_b64_tr_b16 a[158:159], v110 offset:62976
  v_mfma_f32_16x16x32_bf16 v[70:73], v[252:255], v[74:77], v[70:73]
  ds_read_b64_tr_b16 a[160:161], v111 offset:61440
  v_mfma_f32_16x16x32_bf16 v[70:73], v[248:251], v[78:81], v[70:73]
  ds_read_b64_tr_b16 a[162:163], v111 offset:62976
  v_mfma_f32_16x16x32_bf16 v[70:73], v[244:247], v[82:85], v[70:73]
  ds_read_b64_tr_b16 a[164:165], v112 offset:61440
  v_mfma_f32_16x16x32_bf16 v[70:73], v[240:243], v[86:89], v[70:73]
  ds_read_b64_tr_b16 a[166:167], v112 offset:62976
  v_mfma_f32_16x16x32_bf16 v[70:73], v[236:239], v[90:93], v[70:73]
  ds_write_b128 v36, v[66:69] offset:24576
  v_mfma_f32_16x16x32_bf16 v[70:73], v[232:235], v[94:97], v[70:73]
  v_mfma_f32_16x16x32_bf16 v[70:73], v[228:231], v[98:101], v[70:73]
  v_mfma_f32_16x16x32_bf16 v[70:73], v[224:227], v[102:105], v[70:73]
  s_mul_i32 s7, s58, 8320
  s_lshl_b32 s79, s3, 11
  s_add_u32 s7, s7, s79
  s_add_u32 s7, s7, 2097152
  s_add_u32 s7, s7, s61
  s_lshl_b32 s74, s56, 19
  s_add_u32 s74, s74, 8388608
  s_add_u32 s58, s74, 262144
  s_add_u32 s59, s74, 294912
  s_add_u32 s60, s74, 32768
  ds_write_b128 v36, v[70:73] offset:25600
  s_waitcnt vmcnt(8)
  s_waitcnt lgkmcnt(0)
  s_barrier
  ds_read_b128 v[74:77], v37 offset:0
  ds_read_b128 v[78:81], v37 offset:2048
  ds_read_b128 v[82:85], v37 offset:4096
  ds_read_b128 v[86:89], v37 offset:6144
  ds_read_b128 v[90:93], v37 offset:1024
  ds_read_b128 v[94:97], v37 offset:3072
  ds_read_b128 v[98:101], v37 offset:5120
  ds_read_b128 v[102:105], v37 offset:7168
  s_waitcnt lgkmcnt(6)
  v_pk_add_f32 v[74:75], v[74:75], v[78:79]
  v_pk_add_f32 v[76:77], v[76:77], v[80:81]
  s_waitcnt lgkmcnt(4)
  v_pk_add_f32 v[82:83], v[82:83], v[86:87]
  v_pk_add_f32 v[84:85], v[84:85], v[88:89]
  v_cvt_pk_bf16_f32 v42, v74, v82
  v_cvt_pk_bf16_f32 v43, v75, v83
  v_cvt_pk_bf16_f32 v44, v76, v84
  v_cvt_pk_bf16_f32 v45, v77, v85
  buffer_store_dwordx4 v[42:45], v108, s[32:35], s7 offen offset:0 sc1
  s_waitcnt lgkmcnt(2)
  v_pk_add_f32 v[90:91], v[90:91], v[94:95]
  v_pk_add_f32 v[92:93], v[92:93], v[96:97]
  s_waitcnt lgkmcnt(0)
  v_pk_add_f32 v[98:99], v[98:99], v[102:103]
  v_pk_add_f32 v[100:101], v[100:101], v[104:105]
  v_cvt_pk_bf16_f32 v46, v90, v98
  v_cvt_pk_bf16_f32 v47, v91, v99
  v_cvt_pk_bf16_f32 v48, v92, v100
  v_cvt_pk_bf16_f32 v49, v93, v101
  buffer_store_dwordx4 v[46:49], v108, s[32:35], s7 offen offset:1024 sc1
  s_add_u32 s72, s75, 3
  s_and_b32 s72, s72, 3
  s_mul_i32 s72, s72, 43008
  s_add_u32 s72, s72, s65
  v_add_u32 v113, 133120, v113
  v_add_u32 v114, 133120, v114
  v_add_u32 v115, 133120, v115
  v_add_u32 v116, 133120, v116
  ds_read_b64_tr_b16 a[224:225], v113 offset:0
  ds_read_b64_tr_b16 a[226:227], v113 offset:14336
  ds_read_b64_tr_b16 a[228:229], v113 offset:8
  ds_read_b64_tr_b16 a[230:231], v113 offset:14344
  ds_read_b64_tr_b16 a[232:233], v114 offset:0
  ds_read_b64_tr_b16 a[234:235], v114 offset:14336
  ds_read_b64_tr_b16 a[236:237], v114 offset:8
  ds_read_b64_tr_b16 a[238:239], v114 offset:14344
  ds_read_b64_tr_b16 a[240:241], v115 offset:0
  ds_read_b64_tr_b16 a[242:243], v115 offset:14336
  s_add_u32 m0, s85, 77824
  s_nop 0
  buffer_load_dwordx4 v118, s[28:31], s70 offen offset:0 lds
  ds_read_b64_tr_b16 a[244:245], v115 offset:8
  ds_read_b64_tr_b16 a[246:247], v115 offset:14344
  ds_read_b64_tr_b16 a[248:249], v116 offset:0
  ds_read_b64_tr_b16 a[250:251], v116 offset:14336
  v_lshrrev_b32 v161, 8, v118
  v_bfe_u32 v162, v118, 6, 2
  v_lshl_add_u32 v160, v161, 3, v162
  v_lshlrev_b32 v160, 6, v160
  v_bfe_u32 v162, v118, 4, 2
  v_lshl_add_u32 v160, v162, 3, v160
  v_and_b32 v161, 1, v161
  v_lshl_add_u32 v160, v161, 5, v160
  s_lshl_b32 s5, s3, 11
  s_add_u32 s5, s5, 2048
  s_add_u32 s6, s5, 24576
  s_cmp_ge_u32 s3, 2
  s_cselect_b32 s6, 65536, s6
  v_add_u32 v162, s6, v160
  v_add_u32 v160, s5, v160
  v_xor_b32 v161, 32, v160
  v_xor_b32 v163, 32, v162
  v_add_u32 v164, s5, v118
  buffer_load_dwordx4 v119, s[28:31], s70 offen offset:1024 lds
  v_add_u32 v165, s6, v118
  s_waitcnt vmcnt(4)
  ds_read_b64_tr_b16 v[128:129], v160 offset:0
  ds_read_b64_tr_b16 v[130:131], v160 offset:256
  ds_read_b64_tr_b16 v[132:133], v161 offset:0
  ds_read_b64_tr_b16 v[134:135], v161 offset:256
  ds_read_b64_tr_b16 v[136:137], v160 offset:8192
  ds_read_b64_tr_b16 v[138:139], v160 offset:8448
  ds_read_b64_tr_b16 v[140:141], v161 offset:8192
  ds_read_b64_tr_b16 v[142:143], v161 offset:8448
  ds_read_b64_tr_b16 v[144:145], v160 offset:16384
  ds_read_b64_tr_b16 v[146:147], v160 offset:16640
  ds_read_b64_tr_b16 v[148:149], v161 offset:16384
  ds_read_b64_tr_b16 v[150:151], v161 offset:16640
  ds_read_b64_tr_b16 v[152:153], v162 offset:0
  buffer_load_dwordx4 v120, s[28:31], s70 offen offset:2048 lds
  ds_read_b64_tr_b16 v[154:155], v162 offset:256
  ds_read_b64_tr_b16 v[156:157], v163 offset:0
  ds_read_b64_tr_b16 v[158:159], v163 offset:256
  s_waitcnt lgkmcnt(14)
  ds_write_b128 v164, v[128:131] offset:0
  s_waitcnt lgkmcnt(13)
  ds_write_b128 v164, v[132:135] offset:1024
  buffer_load_dwordx4 v121, s[28:31], s70 offen offset:3072 lds
  s_add_u32 m0, m0, 4096
  s_waitcnt lgkmcnt(12)
  ds_write_b128 v164, v[136:139] offset:8192
  s_waitcnt lgkmcnt(11)
  ds_write_b128 v164, v[140:143] offset:9216
  buffer_load_dwordx4 v122, s[28:31], s70 offen offset:0 lds
  s_waitcnt lgkmcnt(10)
  ds_write_b128 v164, v[144:147] offset:16384
  s_waitcnt lgkmcnt(9)
  ds_write_b128 v164, v[148:151] offset:17408
  buffer_load_dwordx4 v123, s[28:31], s70 offen offset:1024 lds
  s_waitcnt lgkmcnt(8)
  ds_write_b128 v165, v[152:155] offset:0
  s_waitcnt lgkmcnt(7)
  ds_write_b128 v165, v[156:159] offset:1024
  buffer_load_dwordx4 v124, s[28:31], s70 offen offset:2048 lds
  s_getreg_b32 s81, hwreg(HW_REG_XCC_ID, 0, 4)
  s_and_b32 s6, s2, 7
  s_lshl_b32 s6, s6, 5
  s_lshr_b32 s5, s2, 3
  s_add_u32 s5, s5, s6
  s_lshl_b32 s6, s3, 8
  s_add_u32 s5, s5, s6
  s_and_b32 s6, s5, 3
  s_lshr_b32 s5, s5, 2
  s_lshl_b32 s5, s5, 7
  s_lshl2_add_u32 s5, s6, s5
  s_add_u32 s7, s5, 1998848
  s_xor_b32 s5, s4, s81
  v_mov_b32 v92, s5
  s_waitcnt vmcnt(7)
  buffer_store_dword v92, v2, s[32:35], s7 offen sc1
  s_waitcnt lgkmcnt(0)
  s_barrier
  s_lshr_b32 s78, s56, 3
  s_lshl_b32 s78, s78, 13
  s_add_u32 s78, s78, 1998848
  s_and_b32 s6, s2, 7
  s_lshl_b32 s6, s6, 5
  s_lshr_b32 s5, s2, 3
  s_add_u32 s5, s5, s6
  s_and_b32 s5, s5, 248
  v_and_b32 v94, 7, v1
  v_lshl_add_u32 v94, v94, 0, s5
  v_lshrrev_b32 v89, 2, v94
  v_lshlrev_b32 v89, 5, v89
  v_and_or_b32 v89, v94, 3, v89
  v_lshlrev_b32 v89, 2, v89
  v_lshl_add_u32 v94, s3, 6, v1
  v_lshrrev_b32 v88, 2, v94
  v_lshlrev_b32 v88, 5, v88
  v_and_or_b32 v88, v94, 3, v88
  v_lshlrev_b32 v88, 2, v88
  s_add_u32 m0, s85, 106496
  s_nop 0
  buffer_load_dwordx4 v118, s[28:31], s68 offen offset:0 lds
  s_mov_b32 s7, 1073741824
  v_bfe_u32 v74, v1, 2, 2
  v_lshlrev_b32 v74, 16, v74
  s_and_b32 s5, s3, 1
  s_and_b32 s6, s57, 1
  s_lshl1_add_u32 s5, s5, s6
  s_and_b32 s6, s57, 6
  s_lshl3_add_u32 s5, s5, s6
  s_lshr_b32 s6, s3, 1
  s_add_u32 s5, s5, s6
  s_lshl_b32 s5, s5, 10
  s_add_u32 s6, s5, 384
  v_bfe_u32 v75, v1, 1, 1
  v_mul_u32_u24 v75, 512, v75
  v_and_b32 v76, 1, v1
  v_lshl_add_u32 v75, v76, 6, v75
  v_and_or_b32 v75, v1, 48, v75
  v_add3_u32 v9, v74, s5, v75
  buffer_load_dwordx4 v119, s[28:31], s68 offen offset:1024 lds
  v_and_b32 v77, 3, v1
  v_lshl_add_u32 v74, v76, 6, v74
  v_and_b32 v75, 2, v1
  v_lshl_add_u32 v74, v75, 4, v74
  v_bfe_u32 v75, v1, 5, 1
  v_lshl_add_u32 v75, v75, 4, v74
  v_lshlrev_b32 v76, 26, v1
  v_and_b32 v76, 1073741824, v76
  v_add3_u32 v10, v75, s6, v76
  s_lshr_b32 s6, s3, 1
  s_lshl_b32 s5, s6, 9
  s_lshl_b32 s6, s6, 5
  v_bfe_u32 v74, v1, 2, 2
  v_mov_b32 v75, s5
  v_mov_b32 v76, s6
  v_cmp_eq_u32 vcc, 3, v74
  v_lshlrev_b32 v74, 7, v74
  v_lshl_add_u32 v74, v77, 4, v74
  v_cndmask_b32 v75, v75, v76, vcc
  buffer_load_dwordx4 v120, s[28:31], s68 offen offset:2048 lds
  v_lshrrev_b32 v76, 4, v1
  v_lshl_add_u32 v74, v76, 13, v74
  s_lshl_b32 s5, s57, 16
  s_and_b32 s6, s3, 1
  s_lshl_b32 s6, s6, 6
  s_add_u32 s5, s5, s6
  v_xad_u32 v74, v74, v75, s5
  v_and_b32 v75, 15, v1
  v_add_lshl_u32 v75, v75, 2, 26
  v_and_or_b32 v11, v75, s7, v74
  v_and_b32 v77, 48, v118
  v_and_b32 v76, 1073741824, v16
  s_lshr_b32 s5, s57, 2
  s_mul_i32 s5, s5, 14336
  s_and_b32 s6, s57, 3
  s_lshl_b32 s6, s6, 6
  s_add_u32 s5, s5, s6
  v_add3_u32 v75, v77, s5, v76
  buffer_load_dwordx4 v121, s[28:31], s68 offen offset:3072 lds
  s_add_u32 m0, m0, 4096
  s_mul_i32 s5, s3, 14
  s_lshl_b32 s6, s80, 2
  s_sub_u32 s5, s5, s6
  v_lshrrev_b32 v74, 2, v1
  v_add_u32 v74, s5, v74
  v_add_u32 v76, 56, v74
  v_min_u32 v74, v74, v76
  v_lshl_add_u32 v12, v74, 8, v75
  s_and_b32 s5, s3, 1
  s_lshr_b32 s6, s3, 1
  v_add_u32 v3, 106496, v118
  v_add_u32 v4, 77824, v118
  s_lshl_b32 s6, s6, 10
  s_add_u32 s7, s6, 2048
  v_add_u32 v7, s7, v118
  s_mul_i32 s7, s5, 14336
  v_add_u32 v17, s7, v3
  s_lshl_b32 s7, s3, 10
  buffer_load_dwordx4 v122, s[28:31], s68 offen offset:0 lds
  v_add_u32 v13, s7, v118
  v_add_u32 v5, s7, v4
  s_lshl3_add_u32 s7, s5, s6
  s_add_u32 s7, s7, 4096
  v_add_u32 v6, s7, v4
  s_add_u32 s7, s3, s75
  s_and_b32 s7, s7, 3
  s_mul_i32 s7, s7, 192
  s_lshl2_add_u32 s7, s62, s7
  v_and_b32 v8, 48, v1
  v_add_u32 v8, s7, v8
  s_cmp_eq_u32 s3, 0
  s_cselect_b32 s77, 0, 1073741824
  s_mul_i32 s5, s3, 224
  v_lshrrev_b32 v102, 2, v3
  v_and_b32 v102, 0xf0, v102
  v_and_b32 v103, 1073741824, v16
  v_add3_u32 v102, v102, s5, v103
  buffer_load_dwordx4 v[98:101], v102, s[52:55], 0 offen
  buffer_load_dwordx4 v123, s[28:31], s68 offen offset:1024 lds
  ds_read_b128 v[58:61], v15 offset:0
  ds_read_b128 v[62:65], v15 offset:64
  s_waitcnt lgkmcnt(1)
  v_pk_add_f32 v[58:59], v[58:59], v[60:61]
  s_waitcnt lgkmcnt(0)
  v_pk_add_f32 v[62:63], v[62:63], v[64:65]
  v_add_f32 v58, v58, v59
  buffer_load_dwordx4 v124, s[28:31], s68 offen offset:2048 lds
  v_add_f32 v62, v62, v63
  v_mul_f32 v59, 0x3b124925, v58
  v_mul_f32 v62, 0x3b124925, v62
  v_fma_f32 v62, -v59, v59, v62
  v_max_f32 v62, 0, v62
  v_add_f32 v60, 0x3727c5ac, v62
  v_rsq_f32 v58, v60
  s_nop 0
  v_mul_f32 v58, s83, v58
  v_mul_f32_e64 v59, -v59, v58
  ds_read_b128 v[66:69], v15 offset:256
  ds_read_b128 v[70:73], v15 offset:320
  s_add_u32 m0, s85, 49152
  s_nop 0
  buffer_load_dwordx4 v118, s[28:31], s72 offen offset:0 lds
  s_waitcnt lgkmcnt(1)
  v_pk_add_f32 v[66:67], v[66:67], v[68:69]
  s_waitcnt lgkmcnt(0)
  v_pk_add_f32 v[70:71], v[70:71], v[72:73]
  v_add_f32 v66, v66, v67
  v_add_f32 v70, v70, v71
  v_mul_f32 v67, 0x3b124925, v66
  v_mul_f32 v70, 0x3b124925, v70
  v_fma_f32 v70, -v67, v67, v70
  v_max_f32 v70, 0, v70
  v_add_f32 v68, 0x3727c5ac, v70
  v_rsq_f32 v66, v68
  s_nop 0
  v_mul_f32 v66, s83, v66
  v_mul_f32_e64 v67, -v67, v66
  v_and_b32 v33, s71, v25
  v_lshlrev_b32 v32, 16, v25
  v_and_b32 v31, s71, v24
  v_lshlrev_b32 v30, 16, v24
  buffer_load_dwordx4 v119, s[28:31], s72 offen offset:1024 lds
  v_and_b32 v29, s71, v23
  v_lshlrev_b32 v28, 16, v23
  v_and_b32 v27, s71, v22
  v_lshlrev_b32 v26, 16, v22
  v_and_b32 v25, s71, v21
  v_lshlrev_b32 v24, 16, v21
  v_and_b32 v23, s71, v20
  v_lshlrev_b32 v22, 16, v20
  v_and_b32 v21, s71, v19
  v_lshlrev_b32 v20, 16, v19
  v_and_b32 v19, s71, v18
  v_lshlrev_b32 v18, 16, v18
  v_pk_fma_f32 v[42:43], v[18:19], v[58:59], v[58:59] op_sel:[0,0,1] op_sel_hi:[1,0,1]
  v_pk_fma_f32 v[44:45], v[20:21], v[58:59], v[58:59] op_sel:[0,0,1] op_sel_hi:[1,0,1]
  v_pk_fma_f32 v[46:47], v[22:23], v[58:59], v[58:59] op_sel:[0,0,1] op_sel_hi:[1,0,1]
  buffer_load_dwordx4 v120, s[28:31], s72 offen offset:2048 lds
  v_pk_fma_f32 v[48:49], v[24:25], v[58:59], v[58:59] op_sel:[0,0,1] op_sel_hi:[1,0,1]
  v_pk_fma_f32 v[50:51], v[26:27], v[66:67], v[66:67] op_sel:[0,0,1] op_sel_hi:[1,0,1]
  v_pk_fma_f32 v[52:53], v[28:29], v[66:67], v[66:67] op_sel:[0,0,1] op_sel_hi:[1,0,1]
  v_pk_fma_f32 v[54:55], v[30:31], v[66:67], v[66:67] op_sel:[0,0,1] op_sel_hi:[1,0,1]
  v_pk_fma_f32 v[56:57], v[32:33], v[66:67], v[66:67] op_sel:[0,0,1] op_sel_hi:[1,0,1]
  v_pk_mul_f32 v[18:19], v[18:19], s[82:83] op_sel:[0,1] op_sel_hi:[1,1]
  v_pk_mul_f32 v[20:21], v[20:21], s[82:83] op_sel:[0,1] op_sel_hi:[1,1]
  v_pk_mul_f32 v[22:23], v[22:23], s[82:83] op_sel:[0,1] op_sel_hi:[1,1]
  v_pk_mul_f32 v[24:25], v[24:25], s[82:83] op_sel:[0,1] op_sel_hi:[1,1]
  buffer_load_dwordx4 v121, s[28:31], s72 offen offset:3072 lds
  s_add_u32 m0, m0, 4096
  v_pk_mul_f32 v[26:27], v[26:27], s[82:83] op_sel:[0,1] op_sel_hi:[1,1]
  v_pk_mul_f32 v[28:29], v[28:29], s[82:83] op_sel:[0,1] op_sel_hi:[1,1]
  v_pk_mul_f32 v[30:31], v[30:31], s[82:83] op_sel:[0,1] op_sel_hi:[1,1]
  v_pk_mul_f32 v[32:33], v[32:33], s[82:83] op_sel:[0,1] op_sel_hi:[1,1]
  v_lshrrev_b32 v93, 2, v1
  v_mad_u32_u24 v93, s3, 14, v93
  s_mov_b32 s6, 33280
  v_mul_lo_u32 v93, v93, s6
  v_and_b32 v97, 3, v1
  v_lshl_add_u32 v93, v97, 3, v93
  v_and_b32 v94, 1073741824, v16
  s_lshl_b32 s6, s56, 3
  s_add_u32 s6, s6, s57
  s_lshl_b32 s6, s6, 5
  s_add_u32 s6, s6, 2097152
  buffer_load_dwordx4 v122, s[28:31], s72 offen offset:0 lds
  v_add3_u32 v104, v93, s6, v94
  v_and_b32 v97, 31, v1
  s_lshl_b32 s6, s56, 10
  v_lshl_add_u32 v1, v97, 2, s6
  v_and_b32 v97, 7, v97
  v_lshl_add_u32 v97, v97, 7, s6
  s_mov_b32 s76, 16384
  buffer_load_dword v97, v97, s[32:35], s76 offen
  s_mul_i32 s73, s56, 57344
  s_add_u32 s5, s3, s75
  s_and_b32 s5, s5, 3
  s_mul_i32 s5, s5, 48
  s_add_u32 s5, s5, s62
  s_lshr_b32 s6, s3, 1
  buffer_load_dwordx4 v123, s[28:31], s72 offen offset:1024 lds
  s_lshl_b32 s7, s6, 4
  s_add_u32 s7, s7, s63
  s_sub_u32 s66, s7, s5
  s_lshl_b32 s66, s66, 2
  s_lshl_b32 s67, s3, 13
  s_lshl_b32 s5, s57, 16
  s_add_u32 s5, s5, s67
  s_sub_u32 s63, s5, 106496
  s_add_u32 s62, s67, 139264
  s_cmp_eq_u32 s3, 3
  s_cselect_b32 s62, 77824, s62
  s_mul_i32 s84, s3, 3584
  s_add_u32 s84, s84, 135168
  s_and_b32 s5, s3, 1
  s_mul_i32 s5, s5, 7168
  s_lshl_b32 s6, s6, 3
  s_add_u32 s5, s5, s6
  v_add_u32 v0, s5, v4
  buffer_load_dwordx4 v124, s[28:31], s72 offen offset:2048 lds
  buffer_load_dword v90, v88, s[32:35], s78 offen sc1
  buffer_load_dword v91, v89, s[32:35], s78 offen sc1
  s_add_u32 s100, s3, 4261412864
  s_mov_b32 s101, 1
  s_mov_b64 exec, 0
  s_branch L_visit
L_site1:
  s_waitcnt vmcnt(1)
  v_xor_b32 v90, s4, v90
  s_waitcnt vmcnt(0)
  v_xor_b32 v91, s4, v91
  v_or_b32 v90, v90, v91
  v_cmp_lt_u32 vcc, 15, v90
  s_cbranch_vccnz L_spin1
L_done1:
  s_barrier
  s_mov_b32 s6, 0
  buffer_load_dwordx2 v[34:35], v104, s[32:35], s6 offen sc1
  s_mov_b32 s6, 8320
  buffer_load_dwordx2 v[36:37], v104, s[32:35], s6 offen sc1
  s_mov_b32 s6, 16640
  buffer_load_dwordx2 v[38:39], v104, s[32:35], s6 offen sc1
  s_mov_b32 s6, 24960
  buffer_load_dwordx2 v[40:41], v104, s[32:35], s6 offen sc1
  v_cmp_ne_u32 vcc, s81, v91
  s_cmp_eq_u32 s2, 0
  s_cselect_b32 s6, 0, 1073741824
  s_add_u32 s6, s6, s77
  v_mov_b32 v93, s4
  buffer_store_dword v93, v2, s[32:35], s6 offen sc1
  s_cmp_lg_u64 vcc, 0
  s_cselect_b32 s82, 1, 0
  s_and_b32 s5, s2, 7
  s_cmp_eq_u32 s5, 7
  s_cselect_b32 s6, 0, s5
  s_mul_i32 s6, s6, 262144
  s_add_u32 s6, s6, 147456
  s_cmp_lg_u32 s61, 0
  s_cselect_b32 s6, 6029312, s6
  s_mul_i32 s5, s5, 229376
  s_sub_u32 s5, s6, s5
  s_cmp_lg_u32 s82, 0
  s_cselect_b32 s5, 4194304, s5
  s_add_u32 s73, s73, s5
  s_lshl_b32 s5, s56, 10
  s_lshl4_add_u32 s5, s57, s5
  s_lshl2_add_u32 s5, s3, s5
  s_lshl_b32 s76, s82, 15
  s_add_u32 m0, s85, 135168
  s_nop 0
  buffer_load_dwordx4 v118, s[28:31], s69 offen offset:0 lds
  s_add_u32 s76, s76, 16384
  s_add_u32 s64, s5, s76
  s_mul_i32 s77, s3, 2560
  s_add_u32 s77, s77, s73
  s_add_u32 s77, s77, 28672
  s_lshr_b32 s75, s57, 2
  s_mul_i32 s75, s75, 28672
  s_sub_u32 s75, s73, s75
  s_add_u32 s75, s75, 43008
  s_mul_i32 s5, s82, 16777216
  s_add_u32 s74, s74, s5
  s_add_u32 s58, s58, s5
  s_add_u32 s59, s59, s5
  s_add_u32 s60, s60, s5
  v_add_u32 v113, 4294909952, v113
  v_add_u32 v114, 4294909952, v114
  v_add_u32 v115, 4294909952, v115
  v_add_u32 v116, 4294909952, v116
  ds_read_b64_tr_b16 v[228:229], v113 offset:0
  ds_read_b64_tr_b16 v[230:231], v113 offset:14336
  ds_read_b64_tr_b16 v[232:233], v113 offset:8
  ds_read_b64_tr_b16 v[234:235], v113 offset:14344
  ds_read_b64_tr_b16 v[236:237], v114 offset:0
  buffer_load_dwordx4 v119, s[28:31], s69 offen offset:1024 lds
  ds_read_b64_tr_b16 v[238:239], v114 offset:14336
  ds_read_b64_tr_b16 v[240:241], v114 offset:8
  ds_read_b64_tr_b16 v[242:243], v114 offset:14344
  ds_read_b64_tr_b16 v[244:245], v115 offset:0
  ds_read_b64_tr_b16 v[246:247], v115 offset:14336
  ds_read_b64_tr_b16 v[248:249], v115 offset:8
  ds_read_b64_tr_b16 v[250:251], v115 offset:14344
  ds_read_b64_tr_b16 v[252:253], v116 offset:0
  ds_read_b64_tr_b16 v[254:255], v116 offset:14336
  ds_read_b64_tr_b16 v[172:173], v113 offset:28672
  ds_read_b64_tr_b16 v[174:175], v113 offset:43008
  ds_read_b64_tr_b16 v[176:177], v113 offset:28680
  buffer_load_dwordx4 v120, s[28:31], s69 offen offset:2048 lds
  ds_read_b64_tr_b16 v[178:179], v113 offset:43016
  ds_read_b64_tr_b16 v[180:181], v114 offset:28672
  ds_read_b64_tr_b16 v[182:183], v114 offset:43008
  ds_read_b64_tr_b16 v[184:185], v114 offset:28680
  ds_read_b64_tr_b16 v[186:187], v114 offset:43016
  ds_read_b64_tr_b16 v[188:189], v115 offset:28672
  ds_read_b64_tr_b16 v[190:191], v115 offset:43008
  ds_read_b64_tr_b16 v[192:193], v115 offset:28680
  ds_read_b64_tr_b16 v[194:195], v115 offset:43016
  ds_read_b64_tr_b16 v[196:197], v116 offset:28672
  ds_read_b64_tr_b16 v[198:199], v116 offset:43008
  v_add_u32 v113, 4294938624, v113
  v_add_u32 v114, 4294938624, v114
  v_add_u32 v115, 4294938624, v115
  buffer_load_dwordx4 v121, s[28:31], s69 offen offset:3072 lds
  s_add_u32 m0, m0, 4096
  v_add_u32 v116, 4294938624, v116
  ds_read_b64_tr_b16 a[252:253], v113 offset:0
  ds_read_b64_tr_b16 a[254:255], v113 offset:14336
  ds_read_b64_tr_b16 v[148:149], v113 offset:8
  ds_read_b64_tr_b16 v[150:151], v113 offset:14344
  ds_read_b64_tr_b16 v[152:153], v114 offset:0
  ds_read_b64_tr_b16 v[154:155], v114 offset:14336
  ds_read_b64_tr_b16 v[156:157], v114 offset:8
  ds_read_b64_tr_b16 v[158:159], v114 offset:14344
  ds_read_b64_tr_b16 v[160:161], v115 offset:0
  ds_read_b64_tr_b16 v[162:163], v115 offset:14336
  ds_read_b64_tr_b16 v[164:165], v115 offset:8
  ds_read_b64_tr_b16 v[166:167], v115 offset:14344
  buffer_load_dwordx4 v122, s[28:31], s69 offen offset:0 lds
  ds_read_b64_tr_b16 v[168:169], v116 offset:0
  ds_read_b64_tr_b16 v[170:171], v116 offset:14336
  s_waitcnt vmcnt(9)
  v_lshlrev_b32 v66, 16, v34
  v_and_b32 v67, s71, v34
  s_waitcnt vmcnt(8)
  v_lshlrev_b32 v68, 16, v36
  v_and_b32 v69, s71, v36
  s_waitcnt vmcnt(7)
  v_lshlrev_b32 v70, 16, v38
  v_and_b32 v71, s71, v38
  s_waitcnt vmcnt(6)
  v_lshlrev_b32 v72, 16, v40
  v_and_b32 v73, s71, v40
  v_pk_fma_f32 v[18:19], v[42:43], v[66:67], v[18:19]
  v_pk_fma_f32 v[20:21], v[44:45], v[68:69], v[20:21]
  v_pk_fma_f32 v[22:23], v[46:47], v[70:71], v[22:23]
  v_pk_fma_f32 v[24:25], v[48:49], v[72:73], v[24:25]
  v_pk_add_f32 v[134:135], v[18:19], v[20:21]
  v_pk_mul_f32 v[136:137], v[18:19], v[18:19]
  v_pk_add_f32 v[138:139], v[22:23], v[24:25]
  v_pk_mul_f32 v[140:141], v[22:23], v[22:23]
  buffer_load_dwordx4 v123, s[28:31], s69 offen offset:1024 lds
  v_pk_fma_f32 v[136:137], v[20:21], v[20:21], v[136:137]
  v_pk_fma_f32 v[140:141], v[24:25], v[24:25], v[140:141]
  v_pk_add_f32 v[134:135], v[134:135], v[138:139]
  v_pk_add_f32 v[136:137], v[136:137], v[140:141]
  v_add_f32 v134, v134, v135
  v_add_f32 v136, v136, v137
  s_nop 1
  v_permlane32_swap_b32 v134, v136
  v_add_f32 v134, v134, v136
  v_mov_b32 v135, v134
  s_nop 1
  v_permlane16_swap_b32 v134, v135
  v_add_f32 v134, v134, v135
  s_nop 1
  v_add_f32_dpp v134, v134, v134 row_ror:8 row_mask:0xf bank_mask:0xf
  s_nop 1
  v_add_f32_dpp v134, v134, v134 row_ror:4 row_mask:0xf bank_mask:0xf
  ds_write_b32 v14, v134 offset:128
  v_lshlrev_b32 v74, 16, v35
  buffer_load_dwordx4 v124, s[28:31], s69 offen offset:2048 lds
  v_and_b32 v75, s71, v35
  v_lshlrev_b32 v76, 16, v37
  v_and_b32 v77, s71, v37
  v_lshlrev_b32 v78, 16, v39
  v_and_b32 v79, s71, v39
  v_lshlrev_b32 v80, 16, v41
  v_and_b32 v81, s71, v41
  v_pk_fma_f32 v[26:27], v[50:51], v[74:75], v[26:27]
  v_pk_fma_f32 v[28:29], v[52:53], v[76:77], v[28:29]
  v_pk_fma_f32 v[30:31], v[54:55], v[78:79], v[30:31]
  v_pk_fma_f32 v[32:33], v[56:57], v[80:81], v[32:33]
  v_pk_add_f32 v[134:135], v[26:27], v[28:29]
  v_pk_mul_f32 v[136:137], v[26:27], v[26:27]
  v_pk_add_f32 v[138:139], v[30:31], v[32:33]
  v_pk_mul_f32 v[140:141], v[30:31], v[30:31]
  v_pk_fma_f32 v[136:137], v[28:29], v[28:29], v[136:137]
  v_pk_fma_f32 v[140:141], v[32:33], v[32:33], v[140:141]
  v_pk_add_f32 v[134:135], v[134:135], v[138:139]
  v_pk_add_f32 v[136:137], v[136:137], v[140:141]
  v_add_f32 v134, v134, v135
  v_add_f32 v136, v136, v137
  s_nop 1
  v_permlane32_swap_b32 v134, v136
  v_add_f32 v134, v134, v136
  v_mov_b32 v135, v134
  s_nop 1
  v_permlane16_swap_b32 v134, v135
  v_add_f32 v134, v134, v135
  s_nop 1
  v_add_f32_dpp v134, v134, v134 row_ror:8 row_mask:0xf bank_mask:0xf
L_hop9:
  s_cbranch_execz L_hopret
  s_nop 1
  v_add_f32_dpp v134, v134, v134 row_ror:4 row_mask:0xf bank_mask:0xf
  ds_write_b32 v14, v134 offset:384
  s_mov_b32 s68, 0x409d30fc
  s_waitcnt lgkmcnt(0)
  s_barrier
  ds_read_b128 v[134:137], v15 offset:128
  ds_read_b128 v[138:141], v15 offset:192
  s_waitcnt lgkmcnt(1)
  v_pk_add_f32 v[134:135], v[134:135], v[136:137]
  s_waitcnt lgkmcnt(0)
  v_pk_add_f32 v[138:139], v[138:139], v[140:141]
  v_add_f32 v134, v134, v135
  v_add_f32 v138, v138, v139
  v_mul_f32 v135, 0x3b124925, v134
  v_mul_f32 v138, 0x3b124925, v138
  v_fma_f32 v138, -v135, v135, v138
  v_max_f32 v138, 0, v138
  v_add_f32 v136, 0x361367a4, v138
  v_rsq_f32 v134, v136
  s_nop 0
  v_mul_f32 v136, v134, v134
  v_fmaak_f32 v136, v136, v138, 0x3727c5ac
  v_rsq_f32 v136, v136
  v_mul_f32 v134, s83, v134
  v_mul_f32 v134, v134, v136
  v_mul_f32_e64 v135, -v135, v134
  v_pk_fma_f32 v[42:43], v[18:19], v[134:135], v[134:135] op_sel:[0,0,1] op_sel_hi:[1,0,1]
  v_pk_fma_f32 v[44:45], v[20:21], v[134:135], v[134:135] op_sel:[0,0,1] op_sel_hi:[1,0,1]
  v_pk_fma_f32 v[46:47], v[22:23], v[134:135], v[134:135] op_sel:[0,0,1] op_sel_hi:[1,0,1]
  v_pk_fma_f32 v[48:49], v[24:25], v[134:135], v[134:135] op_sel:[0,0,1] op_sel_hi:[1,0,1]
  v_cvt_pk_bf16_f32 v126, v42, v43
  v_cvt_pk_bf16_f32 v127, v44, v45
  v_cvt_pk_bf16_f32 v128, v46, v47
  v_cvt_pk_bf16_f32 v129, v48, v49
  buffer_store_dwordx4 v[126:129], v12, s[32:35], s73 offen
  ds_read_b128 v[134:137], v15 offset:384
  ds_read_b128 v[138:141], v15 offset:448
  s_waitcnt lgkmcnt(1)
  v_pk_add_f32 v[134:135], v[134:135], v[136:137]
  s_waitcnt lgkmcnt(0)
  v_pk_add_f32 v[138:139], v[138:139], v[140:141]
  v_add_f32 v134, v134, v135
  v_add_f32 v138, v138, v139
  v_mul_f32 v135, 0x3b124925, v134
  v_mul_f32 v138, 0x3b124925, v138
  v_fma_f32 v138, -v135, v135, v138
  v_max_f32 v138, 0, v138
  v_add_f32 v136, 0x361367a4, v138
  v_rsq_f32 v134, v136
  s_nop 0
  v_mul_f32 v136, v134, v134
  v_fmaak_f32 v136, v136, v138, 0x3727c5ac
  v_rsq_f32 v136, v136
  v_mul_f32 v134, s83, v134
  v_mul_f32 v134, v134, v136
  v_mul_f32_e64 v135, -v135, v134
  v_pk_fma_f32 v[42:43], v[26:27], v[134:135], v[134:135] op_sel:[0,0,1] op_sel_hi:[1,0,1]
  v_pk_fma_f32 v[44:45], v[28:29], v[134:135], v[134:135] op_sel:[0,0,1] op_sel_hi:[1,0,1]
  v_pk_fma_f32 v[46:47], v[30:31], v[134:135], v[134:135] op_sel:[0,0,1] op_sel_hi:[1,0,1]
  v_pk_fma_f32 v[48:49], v[32:33], v[134:135], v[134:135] op_sel:[0,0,1] op_sel_hi:[1,0,1]
  v_cvt_pk_bf16_f32 v130, v42, v43
  v_cvt_pk_bf16_f32 v131, v44, v45
  v_cvt_pk_bf16_f32 v132, v46, v47
  v_cvt_pk_bf16_f32 v133, v48, v49
  s_and_b32 s5, s3, 1
  s_lshl_b32 s6, s5, 1
  s_lshl_b32 s5, s5, 5
  v_lshrrev_b32 v84, 6, v118
  v_subrev_u32 v85, s6, v84
  v_add_u32 v86, 14, v85
  v_min_u32 v85, v85, v86
  v_cmp_gt_u32 vcc, 14, v84
  v_bfe_u32 v86, v118, 4, 2
  s_lshr_b32 s6, s3, 1
  v_cndmask_b32 v84, v84, v85, vcc
  v_lshlrev_b32 v85, 1, v86
  v_xad_u32 v84, v84, v85, s5
  s_lshl_b32 s6, s6, 12
  s_add_u32 s6, s6, 30720
  v_lshl_add_u32 v84, v86, 6, v84
  v_lshl_add_u32 v84, v84, 4, s6
  v_lshlrev_b32 v102, 16, v98
  v_and_b32 v103, s71, v98
  v_lshlrev_b32 v104, 16, v99
  v_and_b32 v105, s71, v99
  v_lshlrev_b32 v106, 16, v100
  v_and_b32 v107, s71, v100
  v_lshlrev_b32 v108, 16, v101
  v_and_b32 v109, s71, v101
  ds_write_b128 v84, v[66:69] offset:16384
  v_mov_b32 v134, s4
  s_waitcnt vmcnt(0)
  s_cmp_lg_u32 s82, 0
  s_cbranch_scc1 L_far2
  buffer_store_dword v134, v2, s[32:35], s64 offen offset:0
L_near2:
  ds_write_b128 v84, v[70:73] offset:16640
  ds_write_b128 v84, v[74:77] offset:24576
  ds_write_b128 v84, v[78:81] offset:24832
  v_fmac_f32 v18, s83, v102
  v_fmac_f32 v19, s83, v103
  v_fmac_f32 v20, s83, v104
  v_fmac_f32 v21, s83, v105
  v_fmac_f32 v22, s83, v106
  v_fmac_f32 v23, s83, v107
  v_fmac_f32 v24, s83, v108
  v_fmac_f32 v25, s83, v109
  v_fmac_f32 v26, s83, v102
  v_fmac_f32 v27, s83, v103
  v_fmac_f32 v28, s83, v104
  v_fmac_f32 v29, s83, v105
  v_fmac_f32 v30, s83, v106
  v_fmac_f32 v31, s83, v107
  v_fmac_f32 v32, s83, v108
  v_fmac_f32 v33, s83, v109
  ds_write_b128 v84, v[102:105] offset:32768
  ds_write_b128 v84, v[106:109] offset:33024
  ds_write_b128 v84, v[18:21] offset:0
  ds_write_b128 v84, v[22:25] offset:256
  buffer_load_dword v135, v1, s[32:35], s76 offen offset:0 sc1
  ds_write_b128 v84, v[26:29] offset:8192
  ds_write_b128 v84, v[30:33] offset:8448
  s_lshl_b32 s5, s3, 5
  s_mov_b32 s6, 30720
  v_xor_b32 v15, s5, v13
  v_add_u32 v15, s6, v15
  v_bfe_u32 v85, v118, 4, 4
  v_lshrrev_b32 v86, 9, v118
  v_lshl_add_u32 v85, v86, 1, v85
  v_add_u32 v87, -14, v85
  v_min_u32 v85, v85, v87
  v_bfe_u32 v87, v118, 8, 1
  v_lshl_add_u32 v86, v87, 1, v86
  v_mad_u32_u24 v85, v86, 14, v85
  v_and_b32 v86, 1073741824, v11
  s_lshl3_add_u32 s5, s56, s57
  s_lshl2_add_u32 s5, s5, s3
  s_mul_i32 s5, s5, 1792
  v_lshl_add_u32 v16, v85, 4, v86
  v_add_u32 v16, s5, v16
  s_lshl_b32 s6, s80, 2
  v_subrev_u32 v85, s6, v85
  v_add_u32 v87, 56, v85
  v_min_u32 v85, v85, v87
  s_lshr_b32 s5, s57, 2
  s_mul_i32 s5, s5, 14336
  s_and_b32 s6, s57, 3
  s_lshl2_add_u32 s6, s6, s3
  s_lshl4_add_u32 s5, s6, s5
  v_lshl_add_u32 v14, v85, 8, v86
  v_add_u32 v14, s5, v14
  v_lshrrev_b32 v85, 2, v118
  v_xor_b32 v85, v85, v118
  v_bfe_u32 v85, v85, 5, 3
  v_bfe_u32 v86, v118, 5, 2
  v_and_or_b32 v85, v85, 4, v86
  v_and_b32 v86, 16, v118
  s_movk_i32 s5, 0x3f80
  v_lshlrev_b32_e64 v86, v86, s5
  v_cmp_eq_u32 vcc, 0, v85
  s_nop 1
  v_cndmask_b32 v62, 0, v86, vcc
  v_cmp_eq_u32 vcc, 1, v85
  s_nop 1
  v_cndmask_b32 v63, 0, v86, vcc
  v_cmp_eq_u32 vcc, 2, v85
  s_nop 1
  v_cndmask_b32 v64, 0, v86, vcc
  v_cmp_eq_u32 vcc, 3, v85
  s_nop 1
  v_cndmask_b32 v65, 0, v86, vcc
  ds_write_b128 v15, v[62:65] offset:40960
  s_waitcnt vmcnt(0)
  v_cmp_ne_u32 vcc, s4, v135
  s_cbranch_vccnz L_spin3
L_done3:
  s_lshl_b32 s5, s3, 10
  s_add_u32 m0, s5, 106496
  s_mov_b32 s6, s73
  buffer_load_dwordx4 v13, s[32:35], s6 offen sc1 lds
  s_add_u32 m0, m0, 4096
  s_add_u32 s6, s6, 4096
  buffer_load_dwordx4 v13, s[32:35], s6 offen sc1 lds
  s_add_u32 m0, m0, 4096
  s_add_u32 s6, s6, 4096
  buffer_load_dwordx4 v13, s[32:35], s6 offen sc1 lds
  s_add_u32 m0, m0, 4096
  s_add_u32 s6, s6, 4096
  buffer_load_dwordx4 v13, s[32:35], s6 offen sc1 lds
  s_add_u32 m0, m0, 4096
  s_add_u32 s6, s6, 4096
  buffer_load_dwordx4 v13, s[32:35], s6 offen sc1 lds
  s_add_u32 m0, m0, 4096
  s_add_u32 s6, s6, 4096
  buffer_load_dwordx4 v13, s[32:35], s6 offen sc1 lds
  s_add_u32 m0, m0, 4096
  s_add_u32 s6, s6, 4096
  buffer_load_dwordx4 v13, s[32:35], s6 offen sc1 lds
  buffer_store_dwordx4 v[130:133], v12, s[32:35], s75 offen
  ds_read_b128 v[42:45], v8 offset:0
  ds_read_b128 v[46:49], v8 offset:64
  ds_read_b128 v[50:53], v8 offset:128
  s_barrier
  v_add_u32 v113, 86016, v113
  v_add_u32 v114, 86016, v114
  v_add_u32 v115, 86016, v115
  v_add_u32 v116, 86016, v116
  ds_read_b64_tr_b16 v[200:201], v113 offset:0
  ds_read_b64_tr_b16 v[202:203], v113 offset:14336
  ds_read_b64_tr_b16 v[204:205], v113 offset:8
  ds_read_b64_tr_b16 v[206:207], v113 offset:14344
  ds_read_b64_tr_b16 v[208:209], v114 offset:0
  ds_read_b64_tr_b16 v[210:211], v114 offset:14336
  ds_read_b64_tr_b16 v[212:213], v114 offset:8
  ds_read_b64_tr_b16 v[214:215], v114 offset:14344
  ds_read_b64_tr_b16 v[216:217], v115 offset:0
  ds_read_b64_tr_b16 v[218:219], v115 offset:14336
  ds_read_b64_tr_b16 v[220:221], v115 offset:8
  ds_read_b64_tr_b16 v[222:223], v115 offset:14344
  ds_read_b64_tr_b16 v[224:225], v116 offset:0
  ds_read_b64_tr_b16 v[226:227], v116 offset:14336
  v_mov_b32 v12, s4
  s_waitcnt lgkmcnt(0)
L_layer:
  s_waitcnt vmcnt(4)
  s_barrier
  ds_read_b128 v[66:69], v3 offset:0
  ds_read_b128 v[70:73], v3 offset:1024
  ds_read_b128 v[74:77], v3 offset:2048
  ds_read_b128 v[78:81], v3 offset:3072
  ds_read_b128 v[54:57], v3 offset:4096
  ds_read_b128 v[58:61], v3 offset:5120
  s_waitcnt lgkmcnt(5)
  v_mfma_f32_16x16x32_bf16 v[42:45], a[0:3], v[66:69], v[42:45]
  v_add_u32 v118, 4294860928, v3
  v_mfma_f32_16x16x32_bf16 v[46:49], a[4:7], v[66:69], v[46:49]
  s_lshr_b32 s7, s57, 2
  v_lshlrev_b32 v118, 20, v118
  v_mfma_f32_16x16x32_bf16 v[50:53], a[8:11], v[66:69], v[50:53]
  s_waitcnt lgkmcnt(4)
  s_mul_i32 s7, s7, -258048
  ds_read_b128 v[66:69], v3 offset:6144
  v_and_b32 v118, 1073741824, v118
  v_mfma_f32_16x16x32_bf16 v[42:45], a[12:15], v[70:73], v[42:45]
  s_add_u32 s7, s7, s74
  v_add3_u32 v118, v3, s63, v118
  v_mfma_f32_16x16x32_bf16 v[46:49], a[16:19], v[70:73], v[46:49]
  s_lshl_b32 s5, s82, 30
  v_lshlrev_b32 v119, 3, v13
  v_mfma_f32_16x16x32_bf16 v[50:53], a[20:23], v[70:73], v[50:53]
  s_waitcnt lgkmcnt(3)
  ds_read_b128 v[70:73], v3 offset:7168
  v_add_u32 v120, 128, v119
  v_mfma_f32_16x16x32_bf16 v[42:45], a[24:27], v[74:77], v[42:45]
  s_add_u32 s7, s7, s5
  ds_read_b128 v[82:85], v7 offset:0
  v_and_b32 v120, 0x380, v120
  v_mfma_f32_16x16x32_bf16 v[46:49], a[28:31], v[74:77], v[46:49]
  s_add_u32 s7, s7, 294912
  ds_read_b128 v[86:89], v7 offset:2048
  v_add_u32 v120, -1, v120
  v_mfma_f32_16x16x32_bf16 v[50:53], a[32:35], v[74:77], v[50:53]
  ds_read_b128 v[74:77], v3 offset:8192
  v_lshl_or_b32 v120, v119, 18, v120
  v_mfma_f32_16x16x32_bf16 v[42:45], a[36:39], v[78:81], v[42:45]
  ds_read_b128 v[90:93], v7 offset:4096
  v_and_b32 v120, 1073741824, v120
  v_mfma_f32_16x16x32_bf16 v[46:49], a[40:43], v[78:81], v[46:49]
  ds_read_b128 v[94:97], v7 offset:6144
  v_or_b32 v119, v119, v120
  v_mfma_f32_16x16x32_bf16 v[50:53], a[44:47], v[78:81], v[50:53]
  s_waitcnt lgkmcnt(7)
  ds_read_b128 v[78:81], v3 offset:9216
  v_mfma_f32_16x16x32_bf16 v[42:45], a[48:51], v[54:57], v[42:45]
  ds_read_b128 v[98:101], v7 offset:8192
  v_mfma_f32_16x16x32_bf16 v[46:49], a[52:55], v[54:57], v[46:49]
  ds_read_b128 v[102:105], v7 offset:10240
  v_mfma_f32_16x16x32_bf16 v[50:53], a[56:59], v[54:57], v[50:53]
  s_waitcnt vmcnt(0)
  ds_read_b128 v[54:57], v3 offset:10240
  v_mfma_f32_16x16x32_bf16 v[42:45], a[60:63], v[58:61], v[42:45]
  s_cmp_lg_u32 s82, 0
  s_cbranch_scc1 L_far4
  buffer_store_dword v12, v2, s[32:35], s64 offen offset:128
L_near4:
  ds_read_b128 v[106:109], v7 offset:12288
  v_mfma_f32_16x16x32_bf16 v[46:49], a[64:67], v[58:61], v[46:49]
  ds_read_b128 v[30:33], v7 offset:14336
  v_mfma_f32_16x16x32_bf16 v[50:53], a[68:71], v[58:61], v[50:53]
  s_waitcnt lgkmcnt(11)
  ds_read_b128 v[58:61], v3 offset:11264
  v_mfma_f32_16x16x32_bf16 v[42:45], a[72:75], v[66:69], v[42:45]
  ds_read_b128 v[34:37], v7 offset:16384
  v_mfma_f32_16x16x32_bf16 v[46:49], a[76:79], v[66:69], v[46:49]
  ds_read_b128 v[38:41], v7 offset:18432
  v_mfma_f32_16x16x32_bf16 v[50:53], a[80:83], v[66:69], v[50:53]
  ds_read_b128 v[66:69], v3 offset:12288
  v_add_u32 v62, s66, v8
  v_mfma_f32_16x16x32_bf16 v[42:45], a[84:87], v[70:73], v[42:45]
  ds_read_b128 v[62:65], v62
  v_mfma_f32_16x16x32_bf16 v[46:49], a[88:91], v[70:73], v[46:49]
  ds_read_b128 v[18:21], v8 offset:0
  v_mfma_f32_16x16x32_bf16 v[50:53], a[92:95], v[70:73], v[50:53]
  s_waitcnt lgkmcnt(11)
  ds_read_b128 v[70:73], v3 offset:13312
  v_mfma_f32_16x16x32_bf16 v[42:45], a[96:99], v[74:77], v[42:45]
  v_mfma_f32_16x16x32_bf16 v[46:49], a[100:103], v[74:77], v[46:49]
  s_barrier
  v_mfma_f32_16x16x32_bf16 v[50:53], a[104:107], v[74:77], v[50:53]
  ds_read_b128 v[74:77], v17 offset:0
  v_mfma_f32_16x16x32_bf16 v[42:45], a[108:111], v[78:81], v[42:45]
  v_mfma_f32_16x16x32_bf16 v[46:49], a[112:115], v[78:81], v[46:49]
  ds_read_b128 v[22:25], v8 offset:64
  v_mfma_f32_16x16x32_bf16 v[50:53], a[116:119], v[78:81], v[50:53]
  s_waitcnt lgkmcnt(8)
  ds_read_b128 v[78:81], v17 offset:1024
  v_mfma_f32_16x16x32_bf16 v[42:45], a[120:123], v[54:57], v[42:45]
  ds_read_b128 v[26:29], v8 offset:128
  v_mfma_f32_16x16x32_bf16 v[46:49], a[124:127], v[54:57], v[46:49]
  v_mfma_f32_16x16x32_bf16 v[50:53], a[128:131], v[54:57], v[50:53]
  ds_read_b128 v[54:57], v17 offset:2048
  v_mfma_f32_16x16x32_bf16 v[42:45], a[132:135], v[58:61], v[42:45]
  v_mfma_f32_16x16x32_bf16 v[46:49], a[136:139], v[58:61], v[46:49]
  v_mfma_f32_16x16x32_bf16 v[50:53], a[140:143], v[58:61], v[50:53]
  s_waitcnt lgkmcnt(5)
  ds_read_b128 v[58:61], v17 offset:3072
  v_mfma_f32_16x16x32_bf16 v[42:45], a[144:147], v[66:69], v[42:45]
  v_mfma_f32_16x16x32_bf16 v[46:49], a[148:151], v[66:69], v[46:49]
  v_mfma_f32_16x16x32_bf16 v[50:53], a[152:155], v[66:69], v[50:53]
  buffer_load_dword v127, v1, s[32:35], s76 offen offset:128 sc1
  ds_read_b128 v[66:69], v17 offset:4096
  v_mfma_f32_16x16x32_bf16 v[42:45], a[156:159], v[70:73], v[42:45]
  s_mov_b32 m0, s84
  v_mfma_f32_16x16x32_bf16 v[46:49], a[160:163], v[70:73], v[46:49]
  s_add_u32 s6, s77, 13824
  v_mfma_f32_16x16x32_bf16 v[50:53], a[164:167], v[70:73], v[50:53]
  s_waitcnt lgkmcnt(4)
  ds_read_b128 v[70:73], v17 offset:5120
  v_mfma_f32_16x16x32_bf16 v[62:65], v[82:85], v[74:77], v[62:65]
  ds_read_b128 v[74:77], v17 offset:6144
  ds_read_b128 v[82:85], v7 offset:20480
  v_mfma_f32_16x16x32_bf16 v[62:65], v[86:89], v[78:81], v[62:65]
  s_waitcnt lgkmcnt(4)
  ds_read_b128 v[78:81], v17 offset:7168
  ds_read_b128 v[86:89], v7 offset:22528
  v_mfma_f32_16x16x32_bf16 v[62:65], v[90:93], v[54:57], v[62:65]
  ds_read_b128 v[54:57], v17 offset:8192
  ds_read_b128 v[90:93], v7 offset:24576
  v_mfma_f32_16x16x32_bf16 v[62:65], v[94:97], v[58:61], v[62:65]
  s_waitcnt lgkmcnt(6)
  ds_read_b128 v[58:61], v17 offset:9216
  ds_read_b128 v[94:97], v7 offset:26624
  v_mfma_f32_16x16x32_bf16 v[62:65], v[98:101], v[66:69], v[62:65]
  ds_read_b128 v[66:69], v17 offset:10240
  v_fma_f32 v134, v42, v42, s68
  v_mfma_f32_16x16x32_bf16 v[62:65], v[102:105], v[70:73], v[62:65]
  s_waitcnt lgkmcnt(6)
  ds_read_b128 v[70:73], v17 offset:11264
  v_fma_f32 v135, v43, v43, s68
  v_mfma_f32_16x16x32_bf16 v[62:65], v[106:109], v[74:77], v[62:65]
  s_waitcnt vmcnt(0)
  ds_read_b128 v[74:77], v17 offset:12288
  v_cmp_ne_u32 vcc, s4, v127
  v_mfma_f32_16x16x32_bf16 v[62:65], v[30:33], v[78:81], v[62:65]
  s_waitcnt lgkmcnt(4)
  ds_read_b128 v[78:81], v17 offset:13312
  v_fma_f32 v136, v44, v44, s68
  v_mfma_f32_16x16x32_bf16 v[62:65], v[34:37], v[54:57], v[62:65]
  s_cbranch_vccnz L_spin5
L_done5:
  ds_read_b128 v[54:57], v3 offset:14336
  v_fma_f32 v137, v45, v45, s68
  v_mfma_f32_16x16x32_bf16 v[62:65], v[38:41], v[58:61], v[62:65]
  s_waitcnt lgkmcnt(3)
  ds_read_b128 v[58:61], v3 offset:15360
  v_mul_f32 v134, v134, v42
  v_mfma_f32_16x16x32_bf16 v[62:65], v[82:85], v[66:69], v[62:65]
  buffer_load_dwordx4 v13, s[32:35], s77 offen offset:0 sc1 lds
  ds_read_b128 v[66:69], v3 offset:16384
  v_mul_f32 v135, v135, v43
  v_mfma_f32_16x16x32_bf16 v[62:65], v[86:89], v[70:73], v[62:65]
  s_waitcnt lgkmcnt(3)
  ds_read_b128 v[70:73], v3 offset:17408
  v_mul_f32 v136, v136, v44
  v_mfma_f32_16x16x32_bf16 v[62:65], v[90:93], v[74:77], v[62:65]
  ds_read_b128 v[74:77], v3 offset:18432
  v_mul_f32 v137, v137, v45
  v_mfma_f32_16x16x32_bf16 v[62:65], v[94:97], v[78:81], v[62:65]
  s_waitcnt lgkmcnt(3)
  ds_read_b128 v[78:81], v3 offset:19456
  v_fma_f32 v138, v46, v46, s68
  v_mfma_f32_16x16x32_bf16 v[18:21], a[0:3], v[54:57], v[18:21]
  buffer_load_dwordx4 v13, s[32:35], s77 offen offset:1024 sc1 lds
  v_exp_f32_e64 v134, -v134
  v_mfma_f32_16x16x32_bf16 v[22:25], a[4:7], v[54:57], v[22:25]
  v_exp_f32_e64 v135, -v135
  v_mfma_f32_16x16x32_bf16 v[26:29], a[8:11], v[54:57], v[26:29]
  ds_read_b128 v[54:57], v3 offset:20480
  v_fma_f32 v139, v47, v47, s68
  v_mfma_f32_16x16x32_bf16 v[18:21], a[12:15], v[58:61], v[18:21]
  buffer_load_dwordx4 v13, s[32:35], s77 offen offset:2048 sc1 lds
  ds_read_b128 v[30:33], v8 offset:0
  v_fma_f32 v140, v48, v48, s68
  v_mfma_f32_16x16x32_bf16 v[22:25], a[16:19], v[58:61], v[22:25]
  ds_read_b128 v[34:37], v8 offset:64
  v_fma_f32 v141, v49, v49, s68
  v_mfma_f32_16x16x32_bf16 v[26:29], a[20:23], v[58:61], v[26:29]
  s_waitcnt lgkmcnt(5)
  ds_read_b128 v[58:61], v3 offset:21504
  v_mul_f32 v138, v138, v46
  v_mfma_f32_16x16x32_bf16 v[18:21], a[24:27], v[66:69], v[18:21]
  buffer_load_dwordx4 v13, s[32:35], s77 offen offset:3072 sc1 lds
  ds_read_b128 v[38:41], v8 offset:128
  v_mul_f32 v139, v139, v47
  v_mfma_f32_16x16x32_bf16 v[22:25], a[28:31], v[66:69], v[22:25]
  s_add_u32 m0, m0, 13824
  v_exp_f32_e64 v136, -v136
  v_mfma_f32_16x16x32_bf16 v[26:29], a[32:35], v[66:69], v[26:29]
  ds_read_b128 v[66:69], v3 offset:22528
  v_mul_f32 v140, v140, v48
  v_mfma_f32_16x16x32_bf16 v[18:21], a[36:39], v[70:73], v[18:21]
  buffer_load_dwordx4 v13, s[32:35], s6 offen offset:0 sc1 lds
  v_exp_f32_e64 v137, -v137
  v_mfma_f32_16x16x32_bf16 v[22:25], a[40:43], v[70:73], v[22:25]
  v_add_f32 v134, 1.0, v134
  v_add_f32 v135, 1.0, v135
  v_mfma_f32_16x16x32_bf16 v[26:29], a[44:47], v[70:73], v[26:29]
  s_waitcnt lgkmcnt(6)
  ds_read_b128 v[70:73], v3 offset:23552
  v_add_f32 v136, 1.0, v136
  v_mfma_f32_16x16x32_bf16 v[18:21], a[48:51], v[74:77], v[18:21]
  buffer_load_dwordx4 v13, s[32:35], s6 offen offset:1024 sc1 lds
  v_add_f32 v137, 1.0, v137
  v_mul_f32 v141, v141, v49
  v_mfma_f32_16x16x32_bf16 v[22:25], a[52:55], v[74:77], v[22:25]
  v_rcp_f32 v134, v134
  v_mfma_f32_16x16x32_bf16 v[26:29], a[56:59], v[74:77], v[26:29]
  ds_read_b128 v[74:77], v3 offset:24576
  v_mfma_f32_16x16x32_bf16 v[18:21], a[60:63], v[78:81], v[18:21]
  buffer_load_dwordx4 v13, s[32:35], s6 offen offset:2048 sc1 lds
  v_rcp_f32 v135, v135
  v_mfma_f32_16x16x32_bf16 v[22:25], a[64:67], v[78:81], v[22:25]
  v_rcp_f32 v136, v136
  v_mfma_f32_16x16x32_bf16 v[26:29], a[68:71], v[78:81], v[26:29]
  s_waitcnt lgkmcnt(4)
  ds_read_b128 v[78:81], v3 offset:25600
  v_mfma_f32_16x16x32_bf16 v[18:21], a[72:75], v[54:57], v[18:21]
  buffer_load_dwordx4 v13, s[32:35], s6 offen offset:3072 sc1 lds
  v_rcp_f32 v137, v137
  v_mfma_f32_16x16x32_bf16 v[22:25], a[76:79], v[54:57], v[22:25]
  v_mul_f32 v134, v134, v42
  v_mul_f32 v135, v135, v43
  v_mfma_f32_16x16x32_bf16 v[26:29], a[80:83], v[54:57], v[26:29]
  ds_read_b128 v[54:57], v3 offset:26624
  v_mul_f32 v136, v136, v44
  v_mfma_f32_16x16x32_bf16 v[18:21], a[84:87], v[58:61], v[18:21]
  v_mul_f32 v137, v137, v45
  v_cvt_pk_bf16_f32 v142, v134, v135
  v_mfma_f32_16x16x32_bf16 v[22:25], a[88:91], v[58:61], v[22:25]
  v_cvt_pk_bf16_f32 v143, v136, v137
  v_fma_f32 v134, v50, v50, s68
  v_mfma_f32_16x16x32_bf16 v[26:29], a[92:95], v[58:61], v[26:29]
  s_waitcnt lgkmcnt(3)
  ds_read_b128 v[58:61], v3 offset:27648
  v_fma_f32 v135, v51, v51, s68
  v_mfma_f32_16x16x32_bf16 v[18:21], a[96:99], v[66:69], v[18:21]
  v_exp_f32_e64 v138, -v138
  v_mfma_f32_16x16x32_bf16 v[22:25], a[100:103], v[66:69], v[22:25]
  v_exp_f32_e64 v139, -v139
  v_mfma_f32_16x16x32_bf16 v[26:29], a[104:107], v[66:69], v[26:29]
  v_exp_f32_e64 v140, -v140
  v_mfma_f32_16x16x32_bf16 v[18:21], a[108:111], v[70:73], v[18:21]
  v_exp_f32_e64 v141, -v141
  v_mfma_f32_16x16x32_bf16 v[22:25], a[112:115], v[70:73], v[22:25]
  v_add_f32 v138, 1.0, v138
  v_add_f32 v139, 1.0, v139
  v_mfma_f32_16x16x32_bf16 v[26:29], a[116:119], v[70:73], v[26:29]
  s_waitcnt lgkmcnt(2)
  v_add_f32 v140, 1.0, v140
  v_add_f32 v141, 1.0, v141
  v_mfma_f32_16x16x32_bf16 v[18:21], a[120:123], v[74:77], v[18:21]
  v_rcp_f32 v138, v138
  v_mfma_f32_16x16x32_bf16 v[22:25], a[124:127], v[74:77], v[22:25]
  v_rcp_f32 v139, v139
  v_mfma_f32_16x16x32_bf16 v[26:29], a[128:131], v[74:77], v[26:29]
  s_waitcnt vmcnt(4)
  s_barrier
  v_mfma_f32_16x16x32_bf16 v[18:21], a[132:135], v[78:81], v[18:21]
  ds_read_b128 v[66:69], v3 offset:28672
  v_fma_f32 v136, v52, v52, s68
  v_mfma_f32_16x16x32_bf16 v[22:25], a[136:139], v[78:81], v[22:25]
  v_rcp_f32 v140, v140
  v_mfma_f32_16x16x32_bf16 v[26:29], a[140:143], v[78:81], v[26:29]
  s_waitcnt lgkmcnt(1)
  ds_read_b128 v[70:73], v3 offset:29696
  v_fma_f32 v137, v53, v53, s68
  v_mfma_f32_16x16x32_bf16 v[18:21], a[144:147], v[54:57], v[18:21]
  v_rcp_f32 v141, v141
  v_mfma_f32_16x16x32_bf16 v[22:25], a[148:151], v[54:57], v[22:25]
  ds_read_b128 v[74:77], v3 offset:30720
  v_mul_f32 v138, v138, v46
  v_mfma_f32_16x16x32_bf16 v[26:29], a[152:155], v[54:57], v[26:29]
  v_mul_f32 v139, v139, v47
  v_mul_f32 v140, v140, v48
  v_mfma_f32_16x16x32_bf16 v[18:21], a[156:159], v[58:61], v[18:21]
  ds_read_b128 v[78:81], v3 offset:31744
  v_mul_f32 v141, v141, v49
  v_mfma_f32_16x16x32_bf16 v[22:25], a[160:163], v[58:61], v[22:25]
  v_cvt_pk_bf16_f32 v144, v138, v139
  v_cvt_pk_bf16_f32 v145, v140, v141
  v_mfma_f32_16x16x32_bf16 v[26:29], a[164:167], v[58:61], v[26:29]
  s_waitcnt lgkmcnt(2)
  ds_read_b128 v[54:57], v3 offset:32768
  v_mul_f32 v134, v134, v50
  v_mfma_f32_16x16x32_bf16 v[30:33], a[0:3], v[66:69], v[30:33]
  v_mul_f32 v135, v135, v51
  v_mul_f32 v136, v136, v52
  v_mfma_f32_16x16x32_bf16 v[34:37], a[4:7], v[66:69], v[34:37]
  ds_read_b128 v[58:61], v3 offset:33792
  v_mul_f32 v137, v137, v53
  v_mfma_f32_16x16x32_bf16 v[38:41], a[8:11], v[66:69], v[38:41]
  ds_read_b128 v[66:69], v3 offset:34816
  v_fma_f32 v138, v62, v62, s68
  v_mfma_f32_16x16x32_bf16 v[30:33], a[12:15], v[70:73], v[30:33]
  ds_write_b128 v5, v[142:145] offset:0
  v_mfma_f32_16x16x32_bf16 v[34:37], a[16:19], v[70:73], v[34:37]
  v_exp_f32_e64 v134, -v134
  v_mfma_f32_16x16x32_bf16 v[38:41], a[20:23], v[70:73], v[38:41]
  s_waitcnt lgkmcnt(4)
  ds_read_b128 v[70:73], v3 offset:35840
  v_fma_f32 v139, v63, v63, s68
  v_mfma_f32_16x16x32_bf16 v[30:33], a[24:27], v[74:77], v[30:33]
  v_exp_f32_e64 v135, -v135
  v_mfma_f32_16x16x32_bf16 v[34:37], a[28:31], v[74:77], v[34:37]
  v_exp_f32_e64 v136, -v136
  v_mfma_f32_16x16x32_bf16 v[38:41], a[32:35], v[74:77], v[38:41]
  ds_read_b128 v[74:77], v3 offset:36864
  v_fma_f32 v140, v64, v64, s68
  v_mfma_f32_16x16x32_bf16 v[30:33], a[36:39], v[78:81], v[30:33]
  v_exp_f32_e64 v137, -v137
  v_mfma_f32_16x16x32_bf16 v[34:37], a[40:43], v[78:81], v[34:37]
  v_add_f32 v134, 1.0, v134
  v_add_f32 v135, 1.0, v135
  v_mfma_f32_16x16x32_bf16 v[38:41], a[44:47], v[78:81], v[38:41]
  s_waitcnt lgkmcnt(4)
  ds_read_b128 v[78:81], v3 offset:37888
  v_add_f32 v136, 1.0, v136
  v_mfma_f32_16x16x32_bf16 v[30:33], a[48:51], v[54:57], v[30:33]
  v_add_f32 v137, 1.0, v137
  v_fma_f32 v141, v65, v65, s68
  v_mfma_f32_16x16x32_bf16 v[34:37], a[52:55], v[54:57], v[34:37]
  v_rcp_f32 v134, v134
  v_mfma_f32_16x16x32_bf16 v[38:41], a[56:59], v[54:57], v[38:41]
  ds_read_b128 v[54:57], v3 offset:38912
  v_mul_f32 v138, v138, v62
  v_mfma_f32_16x16x32_bf16 v[30:33], a[60:63], v[58:61], v[30:33]
  v_rcp_f32 v135, v135
  v_mfma_f32_16x16x32_bf16 v[34:37], a[64:67], v[58:61], v[34:37]
  v_rcp_f32 v136, v136
  v_mfma_f32_16x16x32_bf16 v[38:41], a[68:71], v[58:61], v[38:41]
  s_waitcnt lgkmcnt(3)
  ds_read_b128 v[58:61], v3 offset:39936
  v_mul_f32 v139, v139, v63
  v_mfma_f32_16x16x32_bf16 v[30:33], a[72:75], v[66:69], v[30:33]
  v_rcp_f32 v137, v137
  v_mfma_f32_16x16x32_bf16 v[34:37], a[76:79], v[66:69], v[34:37]
  v_mul_f32 v134, v134, v50
  v_mul_f32 v135, v135, v51
  v_mfma_f32_16x16x32_bf16 v[38:41], a[80:83], v[66:69], v[38:41]
  ds_read_b128 v[66:69], v3 offset:40960
  v_mul_f32 v136, v136, v52
  v_mfma_f32_16x16x32_bf16 v[30:33], a[84:87], v[70:73], v[30:33]
  v_mul_f32 v137, v137, v53
  v_cvt_pk_bf16_f32 v146, v134, v135
  v_mfma_f32_16x16x32_bf16 v[34:37], a[88:91], v[70:73], v[34:37]
  v_cvt_pk_bf16_f32 v147, v136, v137
  v_mul_f32 v140, v140, v64
  v_mfma_f32_16x16x32_bf16 v[38:41], a[92:95], v[70:73], v[38:41]
  s_waitcnt lgkmcnt(3)
  ds_read_b128 v[70:73], v3 offset:41984
  v_mul_f32 v141, v141, v65
  v_mfma_f32_16x16x32_bf16 v[30:33], a[96:99], v[74:77], v[30:33]
  buffer_store_dwordx4 v[120:123], v118, s[32:35], s7 offen offset:0 sc1
  v_exp_f32_e64 v138, -v138
  v_mfma_f32_16x16x32_bf16 v[34:37], a[100:103], v[74:77], v[34:37]
  ds_write_b64 v6, v[146:147] offset:0
  v_mfma_f32_16x16x32_bf16 v[38:41], a[104:107], v[74:77], v[38:41]
  v_exp_f32_e64 v139, -v139
  v_mfma_f32_16x16x32_bf16 v[30:33], a[108:111], v[78:81], v[30:33]
  buffer_store_dwordx4 v[120:123], v118, s[32:35], s7 offen offset:1024 sc1
  v_exp_f32_e64 v140, -v140
  v_mfma_f32_16x16x32_bf16 v[34:37], a[112:115], v[78:81], v[34:37]
  v_exp_f32_e64 v141, -v141
  v_mfma_f32_16x16x32_bf16 v[38:41], a[116:119], v[78:81], v[38:41]
  s_waitcnt lgkmcnt(3)
  v_add_f32 v138, 1.0, v138
  v_add_f32 v139, 1.0, v139
  v_mfma_f32_16x16x32_bf16 v[30:33], a[120:123], v[54:57], v[30:33]
  buffer_store_dwordx4 v[120:123], v118, s[32:35], s7 offen offset:2048 sc1
  v_add_f32 v140, 1.0, v140
  v_add_f32 v141, 1.0, v141
  v_rcp_f32 v138, v138
  v_rcp_f32 v139, v139
  v_rcp_f32 v140, v140
  v_rcp_f32 v141, v141
  v_mul_f32 v138, v138, v62
  v_mul_f32 v139, v139, v63
  v_mul_f32 v140, v140, v64
  v_mul_f32 v141, v141, v65
  v_cvt_pk_bf16_f32 v142, v138, v139
  v_cvt_pk_bf16_f32 v143, v140, v141
  ds_write_b64 v0, v[142:143] offset:6144
  v_mfma_f32_16x16x32_bf16 v[34:37], a[124:127], v[54:57], v[34:37]
  v_fma_f32 v134, v18, v18, s68
  v_fma_f32 v135, v19, v19, s68
  v_mfma_f32_16x16x32_bf16 v[38:41], a[128:131], v[54:57], v[38:41]
  v_fma_f32 v136, v20, v20, s68
  v_fma_f32 v137, v21, v21, s68
  v_mfma_f32_16x16x32_bf16 v[30:33], a[132:135], v[58:61], v[30:33]
  buffer_store_dwordx4 v[120:123], v118, s[32:35], s7 offen offset:3072 sc1
  v_mul_f32 v134, v134, v18
  v_mul_f32 v135, v135, v19
  v_mfma_f32_16x16x32_bf16 v[34:37], a[136:139], v[58:61], v[34:37]
  s_waitcnt vmcnt(4) lgkmcnt(0)
  s_barrier
  v_mfma_f32_16x16x32_bf16 v[38:41], a[140:143], v[58:61], v[38:41]
  ds_read_b128 v[82:85], v4 offset:0
  v_mul_f32 v136, v136, v20
  v_mfma_f32_16x16x32_bf16 v[30:33], a[144:147], v[66:69], v[30:33]
  s_lshl_b32 s5, s57, 16
L_hop0:
  s_cbranch_execz L_hopret
  ds_read_b128 v[86:89], v4 offset:1024
  v_mul_f32 v137, v137, v21
  v_mfma_f32_16x16x32_bf16 v[34:37], a[148:151], v[66:69], v[34:37]
  s_add_u32 s7, s7, s5
  ds_read_b128 v[90:93], v4 offset:2048
  v_fma_f32 v138, v22, v22, s68
  v_mfma_f32_16x16x32_bf16 v[38:41], a[152:155], v[66:69], v[38:41]
  s_movk_i32 m0, 1024
  ds_read_b128 v[94:97], v4 offset:3072
  v_fma_f32 v139, v23, v23, s68
  v_mfma_f32_16x16x32_bf16 v[30:33], a[156:159], v[70:73], v[30:33]
  ds_read_b128 v[98:101], v4 offset:4096
  v_fma_f32 v140, v24, v24, s68
  v_mfma_f32_16x16x32_bf16 v[34:37], a[160:163], v[70:73], v[34:37]
  ds_read_b128 v[102:105], v4 offset:5120
  v_fma_f32 v141, v25, v25, s68
  v_mfma_f32_16x16x32_bf16 v[38:41], a[164:167], v[70:73], v[38:41]
  s_waitcnt lgkmcnt(4)
  ds_read_b128 v[106:109], v4 offset:6144
  v_mul_f32 v138, v138, v22
  v_mfma_f32_16x16x32_bf16 v[110:113], a[168:171], v[82:85], 0
  v_exp_f32_e64 v134, -v134
  v_mfma_f32_16x16x32_bf16 v[114:117], a[172:175], v[82:85], 0
  v_exp_f32_e64 v135, -v135
  v_mfma_f32_16x16x32_bf16 v[110:113], a[196:199], v[86:89], v[110:113]
  v_exp_f32_e64 v136, -v136
  v_mfma_f32_16x16x32_bf16 v[114:117], a[200:203], v[86:89], v[114:117]
  s_waitcnt lgkmcnt(2)
  v_exp_f32_e64 v137, -v137
  v_mfma_f32_16x16x32_bf16 v[110:113], a[224:227], v[90:93], v[110:113]
  v_add_f32 v134, 1.0, v134
  v_add_f32 v135, 1.0, v135
  v_mfma_f32_16x16x32_bf16 v[114:117], a[228:231], v[90:93], v[114:117]
  v_add_f32 v136, 1.0, v136
  v_add_f32 v137, 1.0, v137
  v_mfma_f32_16x16x32_bf16 v[110:113], a[252:255], v[94:97], v[110:113]
  v_rcp_f32 v134, v134
  v_mfma_f32_16x16x32_bf16 v[114:117], v[148:151], v[94:97], v[114:117]
  v_rcp_f32 v135, v135
  v_mfma_f32_16x16x32_bf16 v[110:113], v[172:175], v[98:101], v[110:113]
  v_rcp_f32 v136, v136
  v_mfma_f32_16x16x32_bf16 v[114:117], v[176:179], v[98:101], v[114:117]
  s_waitcnt lgkmcnt(0)
  v_rcp_f32 v137, v137
  v_mfma_f32_16x16x32_bf16 v[110:113], v[200:203], v[102:105], v[110:113]
  v_mul_f32 v134, v134, v18
  v_mul_f32 v135, v135, v19
  v_mfma_f32_16x16x32_bf16 v[114:117], v[204:207], v[102:105], v[114:117]
  v_mul_f32 v136, v136, v20
  v_mul_f32 v137, v137, v21
  v_mfma_f32_16x16x32_bf16 v[110:113], v[228:231], v[106:109], v[110:113]
  buffer_load_dword v119, s[32:35], s7 offen sc1 lds
  v_cvt_pk_bf16_f32 v142, v134, v135
  v_cvt_pk_bf16_f32 v143, v136, v137
  v_mfma_f32_16x16x32_bf16 v[114:117], v[232:235], v[106:109], v[114:117]
  v_mul_f32 v139, v139, v23
  v_mul_f32 v140, v140, v24
  v_mfma_f32_16x16x32_bf16 v[118:121], a[176:179], v[82:85], 0
  v_mul_f32 v141, v141, v25
  v_fma_f32 v134, v26, v26, s68
  v_mfma_f32_16x16x32_bf16 v[122:125], a[180:183], v[82:85], 0
  v_exp_f32_e64 v138, -v138
  v_mfma_f32_16x16x32_bf16 v[118:121], a[204:207], v[86:89], v[118:121]
  v_cvt_pk_bf16_f32 v126, v110, v111
  v_cvt_pk_bf16_f32 v127, v112, v113
  v_mfma_f32_16x16x32_bf16 v[122:125], a[208:211], v[86:89], v[122:125]
  v_cvt_pk_bf16_f32 v128, v114, v115
  v_cvt_pk_bf16_f32 v129, v116, v117
  v_mfma_f32_16x16x32_bf16 v[118:121], a[232:235], v[90:93], v[118:121]
  buffer_store_dwordx4 v[126:129], v9, s[32:35], s74 offen offset:0 sc1
  v_exp_f32_e64 v139, -v139
  v_mfma_f32_16x16x32_bf16 v[122:125], a[236:239], v[90:93], v[122:125]
  v_exp_f32_e64 v140, -v140
  v_mfma_f32_16x16x32_bf16 v[118:121], v[152:155], v[94:97], v[118:121]
  v_exp_f32_e64 v141, -v141
  v_mfma_f32_16x16x32_bf16 v[122:125], v[156:159], v[94:97], v[122:125]
  v_add_f32 v138, 1.0, v138
  v_add_f32 v139, 1.0, v139
  v_mfma_f32_16x16x32_bf16 v[118:121], v[180:183], v[98:101], v[118:121]
  v_add_f32 v140, 1.0, v140
  v_add_f32 v141, 1.0, v141
  v_mfma_f32_16x16x32_bf16 v[122:125], v[184:187], v[98:101], v[122:125]
  v_rcp_f32 v138, v138
  v_mfma_f32_16x16x32_bf16 v[118:121], v[208:211], v[102:105], v[118:121]
  v_rcp_f32 v139, v139
  v_mfma_f32_16x16x32_bf16 v[122:125], v[212:215], v[102:105], v[122:125]
  v_rcp_f32 v140, v140
  v_mfma_f32_16x16x32_bf16 v[118:121], v[236:239], v[106:109], v[118:121]
  v_rcp_f32 v141, v141
  v_mfma_f32_16x16x32_bf16 v[122:125], v[240:243], v[106:109], v[122:125]
  v_mul_f32 v138, v138, v22
  v_mul_f32 v139, v139, v23
  v_mfma_f32_16x16x32_bf16 v[110:113], a[184:187], v[82:85], 0
  v_mul_f32 v140, v140, v24
  v_mul_f32 v141, v141, v25
  v_mfma_f32_16x16x32_bf16 v[114:117], a[188:191], v[82:85], 0
  v_cvt_pk_bf16_f32 v144, v138, v139
  v_cvt_pk_bf16_f32 v145, v140, v141
  v_mfma_f32_16x16x32_bf16 v[110:113], a[212:215], v[86:89], v[110:113]
  v_cvt_pk_bf16_f32 v130, v118, v119
  v_cvt_pk_bf16_f32 v131, v120, v121
  v_mfma_f32_16x16x32_bf16 v[114:117], a[216:219], v[86:89], v[114:117]
  v_cvt_pk_bf16_f32 v132, v122, v123
  v_cvt_pk_bf16_f32 v133, v124, v125
  v_mfma_f32_16x16x32_bf16 v[110:113], a[240:243], v[90:93], v[110:113]
  buffer_store_dwordx4 v[130:133], v9, s[32:35], s74 offen offset:128 sc1
  v_fma_f32 v135, v27, v27, s68
  v_fma_f32 v136, v28, v28, s68
  v_mfma_f32_16x16x32_bf16 v[114:117], a[244:247], v[90:93], v[114:117]
  ds_write_b128 v5, v[142:145] offset:7168
  v_mfma_f32_16x16x32_bf16 v[110:113], v[160:163], v[94:97], v[110:113]
  v_fma_f32 v137, v29, v29, s68
  v_mul_f32 v134, v134, v26
  v_mfma_f32_16x16x32_bf16 v[114:117], v[164:167], v[94:97], v[114:117]
  v_mul_f32 v135, v135, v27
  v_mul_f32 v136, v136, v28
  v_mfma_f32_16x16x32_bf16 v[110:113], v[188:191], v[98:101], v[110:113]
  v_mul_f32 v137, v137, v29
  v_fma_f32 v138, v30, v30, s68
  v_mfma_f32_16x16x32_bf16 v[114:117], v[192:195], v[98:101], v[114:117]
  v_exp_f32_e64 v134, -v134
  v_exp_f32_e64 v135, -v135
  v_exp_f32_e64 v136, -v136
  v_exp_f32_e64 v137, -v137
  v_add_f32 v134, 1.0, v134
  v_add_f32 v135, 1.0, v135
  v_add_f32 v136, 1.0, v136
  v_add_f32 v137, 1.0, v137
  v_rcp_f32 v134, v134
  v_rcp_f32 v135, v135
  v_rcp_f32 v136, v136
  v_rcp_f32 v137, v137
  v_mul_f32 v134, v134, v26
  v_mul_f32 v135, v135, v27
  v_mul_f32 v136, v136, v28
  v_mul_f32 v137, v137, v29
  v_cvt_pk_bf16_f32 v146, v134, v135
  v_cvt_pk_bf16_f32 v147, v136, v137
  ds_write_b64 v6, v[146:147] offset:7168
  v_mfma_f32_16x16x32_bf16 v[110:113], v[216:219], v[102:105], v[110:113]
  v_fma_f32 v139, v31, v31, s68
  v_fma_f32 v140, v32, v32, s68
  v_mfma_f32_16x16x32_bf16 v[114:117], v[220:223], v[102:105], v[114:117]
  v_fma_f32 v141, v33, v33, s68
  v_mul_f32 v138, v138, v30
  v_mfma_f32_16x16x32_bf16 v[110:113], v[244:247], v[106:109], v[110:113]
  v_mul_f32 v139, v139, v31
  v_mul_f32 v140, v140, v32
  v_mfma_f32_16x16x32_bf16 v[114:117], v[248:251], v[106:109], v[114:117]
  s_waitcnt lgkmcnt(0)
  s_barrier
  v_mfma_f32_16x16x32_bf16 v[118:121], a[192:195], v[82:85], 0
  ds_read_b128 v[82:85], v4 offset:7168
  v_mul_f32 v141, v141, v33
  v_mfma_f32_16x16x32_bf16 v[118:121], a[220:223], v[86:89], v[118:121]
  ds_read_b128 v[86:89], v4 offset:8192
  v_cvt_pk_bf16_f32 v126, v110, v111
  v_cvt_pk_bf16_f32 v127, v112, v113
  v_mfma_f32_16x16x32_bf16 v[118:121], a[248:251], v[90:93], v[118:121]
  ds_read_b128 v[90:93], v4 offset:9216
  v_cvt_pk_bf16_f32 v128, v114, v115
  v_cvt_pk_bf16_f32 v129, v116, v117
  v_mfma_f32_16x16x32_bf16 v[118:121], v[168:171], v[94:97], v[118:121]
  buffer_store_dwordx4 v[126:129], v9, s[32:35], s74 offen offset:256 sc1
  ds_read_b128 v[94:97], v4 offset:10240
  v_fma_f32 v134, v34, v34, s68
  v_mfma_f32_16x16x32_bf16 v[118:121], v[196:199], v[98:101], v[118:121]
  ds_read_b128 v[98:101], v4 offset:11264
  v_fma_f32 v135, v35, v35, s68
  v_mfma_f32_16x16x32_bf16 v[118:121], v[224:227], v[102:105], v[118:121]
  ds_read_b128 v[102:105], v4 offset:12288
  v_fma_f32 v136, v36, v36, s68
  v_mfma_f32_16x16x32_bf16 v[118:121], v[252:255], v[106:109], v[118:121]
  s_waitcnt lgkmcnt(4)
  ds_read_b128 v[106:109], v4 offset:13312
  v_fma_f32 v137, v37, v37, s68
  v_mfma_f32_16x16x32_bf16 v[110:113], a[168:171], v[82:85], 0
  v_exp_f32_e64 v138, -v138
  v_mfma_f32_16x16x32_bf16 v[114:117], a[172:175], v[82:85], 0
  v_exp_f32_e64 v139, -v139
  v_mfma_f32_16x16x32_bf16 v[110:113], a[196:199], v[86:89], v[110:113]
  v_cvt_pk_bf16_f32 v130, v118, v119
  v_cvt_pk_bf16_f32 v131, v120, v121
  v_mfma_f32_16x16x32_bf16 v[114:117], a[200:203], v[86:89], v[114:117]
  s_waitcnt lgkmcnt(2)
  v_exp_f32_e64 v140, -v140
  v_mfma_f32_16x16x32_bf16 v[110:113], a[224:227], v[90:93], v[110:113]
  v_permlane16_swap_b32 v130, v132
  v_mfma_f32_16x16x32_bf16 v[114:117], a[228:231], v[90:93], v[114:117]
  ds_read_b128 v[42:45], v7 offset:0
  v_mul_f32 v134, v134, v34
  v_mfma_f32_16x16x32_bf16 v[110:113], a[252:255], v[94:97], v[110:113]
  v_permlane16_swap_b32 v131, v133
  v_mfma_f32_16x16x32_bf16 v[114:117], v[148:151], v[94:97], v[114:117]
  buffer_store_dwordx4 v[130:133], v10, s[32:35], s74 offen offset:0 sc1
  v_exp_f32_e64 v141, -v141
  v_mfma_f32_16x16x32_bf16 v[110:113], v[172:175], v[98:101], v[110:113]
  ds_read_b128 v[46:49], v7 offset:2048
  v_add_f32 v138, 1.0, v138
  v_mfma_f32_16x16x32_bf16 v[114:117], v[176:179], v[98:101], v[114:117]
  s_waitcnt lgkmcnt(2)
  v_add_f32 v139, 1.0, v139
  v_add_f32 v140, 1.0, v140
  v_mfma_f32_16x16x32_bf16 v[110:113], v[200:203], v[102:105], v[110:113]
  v_add_f32 v141, 1.0, v141
  v_mul_f32 v135, v135, v35
  v_mfma_f32_16x16x32_bf16 v[114:117], v[204:207], v[102:105], v[114:117]
  ds_read_b128 v[50:53], v7 offset:4096
  v_mul_f32 v136, v136, v36
  v_mfma_f32_16x16x32_bf16 v[110:113], v[228:231], v[106:109], v[110:113]
  v_rcp_f32 v138, v138
  v_mfma_f32_16x16x32_bf16 v[114:117], v[232:235], v[106:109], v[114:117]
  v_rcp_f32 v139, v139
  v_mfma_f32_16x16x32_bf16 v[118:121], a[176:179], v[82:85], 0
  ds_read_b128 v[18:21], v7 offset:6144
  v_mul_f32 v137, v137, v37
  v_mfma_f32_16x16x32_bf16 v[122:125], a[180:183], v[82:85], 0
  v_rcp_f32 v140, v140
  v_mfma_f32_16x16x32_bf16 v[118:121], a[204:207], v[86:89], v[118:121]
  v_cvt_pk_bf16_f32 v126, v110, v111
  v_cvt_pk_bf16_f32 v127, v112, v113
  v_mfma_f32_16x16x32_bf16 v[122:125], a[208:211], v[86:89], v[122:125]
  ds_read_b128 v[22:25], v7 offset:8192
  v_cvt_pk_bf16_f32 v128, v114, v115
  v_cvt_pk_bf16_f32 v129, v116, v117
  v_mfma_f32_16x16x32_bf16 v[118:121], a[232:235], v[90:93], v[118:121]
  buffer_store_dwordx4 v[126:129], v9, s[32:35], s58 offen offset:0 sc1
  v_rcp_f32 v141, v141
  v_mfma_f32_16x16x32_bf16 v[122:125], a[236:239], v[90:93], v[122:125]
  v_mul_f32 v138, v138, v30
  v_mul_f32 v139, v139, v31
  v_mfma_f32_16x16x32_bf16 v[118:121], v[152:155], v[94:97], v[118:121]
  ds_read_b128 v[26:29], v7 offset:10240
  v_mul_f32 v140, v140, v32
  v_mfma_f32_16x16x32_bf16 v[122:125], v[156:159], v[94:97], v[122:125]
  v_mul_f32 v141, v141, v33
  v_cvt_pk_bf16_f32 v142, v138, v139
  v_mfma_f32_16x16x32_bf16 v[118:121], v[180:183], v[98:101], v[118:121]
  ds_read_b128 v[74:77], v17 offset:28672
  v_add_u32 v62, s66, v8
  v_mfma_f32_16x16x32_bf16 v[122:125], v[184:187], v[98:101], v[122:125]
  ds_read_b128 v[62:65], v62
  v_cvt_pk_bf16_f32 v143, v140, v141
  v_mfma_f32_16x16x32_bf16 v[118:121], v[208:211], v[102:105], v[118:121]
  v_exp_f32_e64 v134, -v134
  v_mfma_f32_16x16x32_bf16 v[122:125], v[212:215], v[102:105], v[122:125]
  ds_read_b128 v[78:81], v17 offset:29696
  v_fma_f32 v138, v38, v38, s68
  v_mfma_f32_16x16x32_bf16 v[118:121], v[236:239], v[106:109], v[118:121]
  v_exp_f32_e64 v135, -v135
  v_mfma_f32_16x16x32_bf16 v[122:125], v[240:243], v[106:109], v[122:125]
  v_exp_f32_e64 v136, -v136
  v_mfma_f32_16x16x32_bf16 v[110:113], a[184:187], v[82:85], 0
  ds_read_b128 v[54:57], v17 offset:30720
  v_fma_f32 v139, v39, v39, s68
  v_mfma_f32_16x16x32_bf16 v[114:117], a[188:191], v[82:85], 0
  v_exp_f32_e64 v137, -v137
  v_mfma_f32_16x16x32_bf16 v[110:113], a[212:215], v[86:89], v[110:113]
  v_cvt_pk_bf16_f32 v130, v118, v119
  v_cvt_pk_bf16_f32 v131, v120, v121
  v_mfma_f32_16x16x32_bf16 v[114:117], a[216:219], v[86:89], v[114:117]
  ds_read_b128 v[58:61], v17 offset:31744
  v_cvt_pk_bf16_f32 v132, v122, v123
  v_cvt_pk_bf16_f32 v133, v124, v125
  v_mfma_f32_16x16x32_bf16 v[110:113], a[240:243], v[90:93], v[110:113]
  buffer_store_dwordx4 v[130:133], v9, s[32:35], s58 offen offset:128 sc1
  v_add_f32 v134, 1.0, v134
  v_add_f32 v135, 1.0, v135
  v_mfma_f32_16x16x32_bf16 v[114:117], a[244:247], v[90:93], v[114:117]
  v_add_f32 v136, 1.0, v136
  v_add_f32 v137, 1.0, v137
  v_mfma_f32_16x16x32_bf16 v[110:113], v[160:163], v[94:97], v[110:113]
  ds_read_b128 v[66:69], v17 offset:32768
  v_fma_f32 v140, v40, v40, s68
  v_mfma_f32_16x16x32_bf16 v[114:117], v[164:167], v[94:97], v[114:117]
  v_rcp_f32 v134, v134
  v_mfma_f32_16x16x32_bf16 v[110:113], v[188:191], v[98:101], v[110:113]
  v_rcp_f32 v135, v135
  v_mfma_f32_16x16x32_bf16 v[114:117], v[192:195], v[98:101], v[114:117]
  ds_read_b128 v[70:73], v17 offset:33792
  v_fma_f32 v141, v41, v41, s68
  v_mfma_f32_16x16x32_bf16 v[110:113], v[216:219], v[102:105], v[110:113]
  v_rcp_f32 v136, v136
  v_mfma_f32_16x16x32_bf16 v[114:117], v[220:223], v[102:105], v[114:117]
  v_rcp_f32 v137, v137
  v_mfma_f32_16x16x32_bf16 v[110:113], v[244:247], v[106:109], v[110:113]
  v_mul_f32 v134, v134, v34
  v_mul_f32 v135, v135, v35
  v_mfma_f32_16x16x32_bf16 v[114:117], v[248:251], v[106:109], v[114:117]
  v_mul_f32 v136, v136, v36
  v_mul_f32 v137, v137, v37
  v_mfma_f32_16x16x32_bf16 v[118:121], a[192:195], v[82:85], 0
  ds_read_b128 v[82:85], v7 offset:12288
  v_cvt_pk_bf16_f32 v144, v134, v135
  v_mfma_f32_16x16x32_bf16 v[118:121], a[220:223], v[86:89], v[118:121]
  ds_read_b128 v[86:89], v7 offset:14336
  v_cvt_pk_bf16_f32 v126, v110, v111
  v_cvt_pk_bf16_f32 v127, v112, v113
  v_mfma_f32_16x16x32_bf16 v[118:121], a[248:251], v[90:93], v[118:121]
  ds_read_b128 v[90:93], v7 offset:16384
  v_cvt_pk_bf16_f32 v128, v114, v115
  v_cvt_pk_bf16_f32 v129, v116, v117
  v_mfma_f32_16x16x32_bf16 v[118:121], v[168:171], v[94:97], v[118:121]
  buffer_store_dwordx4 v[126:129], v9, s[32:35], s58 offen offset:256 sc1
  ds_read_b128 v[94:97], v7 offset:18432
  v_cvt_pk_bf16_f32 v145, v136, v137
  v_mfma_f32_16x16x32_bf16 v[118:121], v[196:199], v[98:101], v[118:121]
  ds_read_b128 v[98:101], v7 offset:20480
  v_mul_f32 v138, v138, v38
  v_mfma_f32_16x16x32_bf16 v[118:121], v[224:227], v[102:105], v[118:121]
  ds_read_b128 v[102:105], v7 offset:22528
  v_mul_f32 v139, v139, v39
  v_mfma_f32_16x16x32_bf16 v[118:121], v[252:255], v[106:109], v[118:121]
  s_waitcnt lgkmcnt(10)
  ds_read_b128 v[106:109], v7 offset:24576
  v_mul_f32 v140, v140, v40
  v_mfma_f32_16x16x32_bf16 v[62:65], v[42:45], v[74:77], v[62:65]
  ds_read_b128 v[74:77], v17 offset:34816
  v_mul_f32 v141, v141, v41
  v_mfma_f32_16x16x32_bf16 v[62:65], v[46:49], v[78:81], v[62:65]
  s_waitcnt lgkmcnt(10)
  ds_read_b128 v[78:81], v17 offset:35840
  s_nop 0
  v_mfma_f32_16x16x32_bf16 v[62:65], v[50:53], v[54:57], v[62:65]
  ds_read_b128 v[54:57], v17 offset:36864
  v_cvt_pk_bf16_f32 v130, v118, v119
  v_cvt_pk_bf16_f32 v131, v120, v121
  v_mfma_f32_16x16x32_bf16 v[62:65], v[18:21], v[58:61], v[62:65]
  s_waitcnt lgkmcnt(10)
  ds_read_b128 v[58:61], v17 offset:37888
  ds_read_b128 v[18:21], v7 offset:26624
  v_mfma_f32_16x16x32_bf16 v[62:65], v[22:25], v[66:69], v[62:65]
  ds_read_b128 v[66:69], v17 offset:38912
  v_permlane16_swap_b32 v130, v132
  v_mfma_f32_16x16x32_bf16 v[62:65], v[26:29], v[70:73], v[62:65]
  s_waitcnt lgkmcnt(4)
  ds_read_b128 v[70:73], v17 offset:39936
  ds_read_b128 v[42:45], v8 offset:0
  v_mfma_f32_16x16x32_bf16 v[62:65], v[82:85], v[74:77], v[62:65]
  ds_read_b128 v[74:77], v17 offset:40960
  v_permlane16_swap_b32 v131, v133
  v_mfma_f32_16x16x32_bf16 v[62:65], v[86:89], v[78:81], v[62:65]
  s_waitcnt lgkmcnt(5)
  buffer_store_dwordx4 v[130:133], v10, s[32:35], s58 offen offset:0 sc1
  ds_read_b128 v[78:81], v17 offset:41984
  ds_read_b128 v[46:49], v8 offset:64
  v_mfma_f32_16x16x32_bf16 v[62:65], v[90:93], v[54:57], v[62:65]
  ds_read_b128 v[54:57], v3 offset:43008
  v_mfma_f32_16x16x32_bf16 v[62:65], v[94:97], v[58:61], v[62:65]
  s_waitcnt lgkmcnt(5)
  ds_read_b128 v[58:61], v3 offset:44032
  ds_read_b128 v[50:53], v8 offset:128
  v_mfma_f32_16x16x32_bf16 v[62:65], v[98:101], v[66:69], v[62:65]
  ds_read_b128 v[66:69], v3 offset:45056
  v_mfma_f32_16x16x32_bf16 v[62:65], v[102:105], v[70:73], v[62:65]
  s_waitcnt lgkmcnt(5)
  ds_read_b128 v[70:73], v3 offset:46080
  v_mfma_f32_16x16x32_bf16 v[62:65], v[106:109], v[74:77], v[62:65]
  ds_read_b128 v[74:77], v3 offset:47104
  v_mfma_f32_16x16x32_bf16 v[62:65], v[18:21], v[78:81], v[62:65]
  s_waitcnt lgkmcnt(4)
  ds_read_b128 v[78:81], v3 offset:48128
  v_mfma_f32_16x16x32_bf16 v[42:45], a[0:3], v[54:57], v[42:45]
  ds_write_b128 v5, v[142:145] offset:14336
  v_mfma_f32_16x16x32_bf16 v[46:49], a[4:7], v[54:57], v[46:49]
  s_waitcnt lgkmcnt(5)
  v_exp_f32_e64 v138, -v138
  v_mfma_f32_16x16x32_bf16 v[50:53], a[8:11], v[54:57], v[50:53]
  ds_read_b128 v[54:57], v3 offset:49152
  v_mfma_f32_16x16x32_bf16 v[42:45], a[12:15], v[58:61], v[42:45]
  v_exp_f32_e64 v139, -v139
  v_mfma_f32_16x16x32_bf16 v[46:49], a[16:19], v[58:61], v[46:49]
  v_exp_f32_e64 v140, -v140
  v_mfma_f32_16x16x32_bf16 v[50:53], a[20:23], v[58:61], v[50:53]
  s_waitcnt lgkmcnt(4)
  ds_read_b128 v[58:61], v3 offset:50176
  v_fma_f32 v134, v62, v62, s68
  v_mfma_f32_16x16x32_bf16 v[42:45], a[24:27], v[66:69], v[42:45]
  v_exp_f32_e64 v141, -v141
  v_mfma_f32_16x16x32_bf16 v[46:49], a[28:31], v[66:69], v[46:49]
  v_add_f32 v138, 1.0, v138
  v_add_f32 v139, 1.0, v139
  v_mfma_f32_16x16x32_bf16 v[50:53], a[32:35], v[66:69], v[50:53]
  ds_read_b128 v[66:69], v3 offset:51200
  v_add_f32 v140, 1.0, v140
  v_mfma_f32_16x16x32_bf16 v[42:45], a[36:39], v[70:73], v[42:45]
  v_add_f32 v141, 1.0, v141
  v_fma_f32 v135, v63, v63, s68
  v_mfma_f32_16x16x32_bf16 v[46:49], a[40:43], v[70:73], v[46:49]
  v_rcp_f32 v138, v138
  v_mfma_f32_16x16x32_bf16 v[50:53], a[44:47], v[70:73], v[50:53]
  s_waitcnt lgkmcnt(4)
  ds_read_b128 v[70:73], v3 offset:52224
  v_fma_f32 v136, v64, v64, s68
  v_mfma_f32_16x16x32_bf16 v[42:45], a[48:51], v[74:77], v[42:45]
  v_rcp_f32 v139, v139
  v_mfma_f32_16x16x32_bf16 v[46:49], a[52:55], v[74:77], v[46:49]
  v_rcp_f32 v140, v140
  v_mfma_f32_16x16x32_bf16 v[50:53], a[56:59], v[74:77], v[50:53]
  ds_read_b128 v[74:77], v3 offset:53248
  v_fma_f32 v137, v65, v65, s68
  v_mfma_f32_16x16x32_bf16 v[42:45], a[60:63], v[78:81], v[42:45]
  v_rcp_f32 v141, v141
  v_mfma_f32_16x16x32_bf16 v[46:49], a[64:67], v[78:81], v[46:49]
  v_mul_f32 v138, v138, v38
  v_mul_f32 v139, v139, v39
  v_mfma_f32_16x16x32_bf16 v[50:53], a[68:71], v[78:81], v[50:53]
  s_waitcnt lgkmcnt(3)
  ds_read_b128 v[78:81], v3 offset:54272
  v_mul_f32 v140, v140, v40
  v_mfma_f32_16x16x32_bf16 v[42:45], a[72:75], v[54:57], v[42:45]
  v_mul_f32 v141, v141, v41
  v_cvt_pk_bf16_f32 v146, v138, v139
  v_mfma_f32_16x16x32_bf16 v[46:49], a[76:79], v[54:57], v[46:49]
  v_cvt_pk_bf16_f32 v147, v140, v141
  v_mul_f32 v134, v134, v62
  v_mfma_f32_16x16x32_bf16 v[50:53], a[80:83], v[54:57], v[50:53]
  ds_read_b128 v[54:57], v3 offset:55296
  v_mul_f32 v135, v135, v63
  v_mfma_f32_16x16x32_bf16 v[42:45], a[84:87], v[58:61], v[42:45]
  ds_write_b64 v6, v[146:147] offset:14336
  v_mfma_f32_16x16x32_bf16 v[46:49], a[88:91], v[58:61], v[46:49]
  v_mul_f32 v136, v136, v64
  v_mul_f32 v137, v137, v65
  v_mfma_f32_16x16x32_bf16 v[50:53], a[92:95], v[58:61], v[50:53]
  s_waitcnt lgkmcnt(4)
  ds_read_b128 v[58:61], v3 offset:56320
  v_mfma_f32_16x16x32_bf16 v[42:45], a[96:99], v[66:69], v[42:45]
  s_waitcnt vmcnt(0)
  v_exp_f32_e64 v134, -v134
  v_mfma_f32_16x16x32_bf16 v[46:49], a[100:103], v[66:69], v[46:49]
  s_cmp_lg_u32 s82, 0
  s_cbranch_scc1 L_far6
  buffer_store_dword v12, v2, s[32:35], s64 offen offset:256
L_near6:
  v_mfma_f32_16x16x32_bf16 v[50:53], a[104:107], v[66:69], v[50:53]
  v_exp_f32_e64 v135, -v135
  v_mfma_f32_16x16x32_bf16 v[42:45], a[108:111], v[70:73], v[42:45]
  v_exp_f32_e64 v136, -v136
  v_mfma_f32_16x16x32_bf16 v[46:49], a[112:115], v[70:73], v[46:49]
  v_exp_f32_e64 v137, -v137
  v_mfma_f32_16x16x32_bf16 v[50:53], a[116:119], v[70:73], v[50:53]
  s_waitcnt lgkmcnt(3)
  v_add_f32 v134, 1.0, v134
  v_add_f32 v135, 1.0, v135
  v_mfma_f32_16x16x32_bf16 v[42:45], a[120:123], v[74:77], v[42:45]
  v_add_f32 v136, 1.0, v136
  v_add_f32 v137, 1.0, v137
  v_rcp_f32 v134, v134
  v_rcp_f32 v135, v135
  v_rcp_f32 v136, v136
  v_rcp_f32 v137, v137
  v_mul_f32 v134, v134, v62
  v_mul_f32 v135, v135, v63
  v_mul_f32 v136, v136, v64
  v_mul_f32 v137, v137, v65
  v_cvt_pk_bf16_f32 v142, v134, v135
  v_cvt_pk_bf16_f32 v143, v136, v137
  ds_write_b64 v0, v[142:143] offset:20480
  v_mfma_f32_16x16x32_bf16 v[46:49], a[124:127], v[74:77], v[46:49]
  v_mfma_f32_16x16x32_bf16 v[50:53], a[128:131], v[74:77], v[50:53]
  v_mfma_f32_16x16x32_bf16 v[42:45], a[132:135], v[78:81], v[42:45]
  v_mfma_f32_16x16x32_bf16 v[46:49], a[136:139], v[78:81], v[46:49]
  s_waitcnt lgkmcnt(0)
  s_barrier
  v_mfma_f32_16x16x32_bf16 v[50:53], a[140:143], v[78:81], v[50:53]
  ds_read_b128 v[82:85], v4 offset:14336
  v_mfma_f32_16x16x32_bf16 v[42:45], a[144:147], v[54:57], v[42:45]
  ds_read_b128 v[86:89], v4 offset:15360
  v_mfma_f32_16x16x32_bf16 v[46:49], a[148:151], v[54:57], v[46:49]
  ds_read_b128 v[90:93], v4 offset:16384
  v_mfma_f32_16x16x32_bf16 v[50:53], a[152:155], v[54:57], v[50:53]
  ds_read_b128 v[94:97], v4 offset:17408
  v_mfma_f32_16x16x32_bf16 v[42:45], a[156:159], v[58:61], v[42:45]
  ds_read_b128 v[98:101], v4 offset:18432
  v_mfma_f32_16x16x32_bf16 v[46:49], a[160:163], v[58:61], v[46:49]
  ds_read_b128 v[102:105], v4 offset:19456
  v_mfma_f32_16x16x32_bf16 v[50:53], a[164:167], v[58:61], v[50:53]
  s_waitcnt lgkmcnt(4)
  ds_read_b128 v[106:109], v4 offset:20480
  v_mfma_f32_16x16x32_bf16 v[110:113], a[168:171], v[82:85], 0
  buffer_load_dword v18, v1, s[32:35], s76 offen offset:256 sc1
  v_mfma_f32_16x16x32_bf16 v[114:117], a[172:175], v[82:85], 0
  s_add_u32 m0, s67, 106496
  v_add_u32 v59, 4294860928, v3
  v_mfma_f32_16x16x32_bf16 v[110:113], a[196:199], v[86:89], v[110:113]
  s_add_u32 s6, s74, 4096
  v_lshlrev_b32 v59, 20, v59
  v_mfma_f32_16x16x32_bf16 v[114:117], a[200:203], v[86:89], v[114:117]
  s_waitcnt lgkmcnt(2)
  v_and_b32 v59, 1073741824, v59
  v_fma_f32 v138, v42, v42, s68
  v_mfma_f32_16x16x32_bf16 v[110:113], a[224:227], v[90:93], v[110:113]
  v_lshrrev_b32 v58, 2, v3
  v_fma_f32 v139, v43, v43, s68
  v_mfma_f32_16x16x32_bf16 v[114:117], a[228:231], v[90:93], v[114:117]
  v_and_or_b32 v59, v58, 64, v59
  v_fma_f32 v140, v44, v44, s68
  v_mfma_f32_16x16x32_bf16 v[110:113], a[252:255], v[94:97], v[110:113]
  v_xad_u32 v58, v3, v59, s63
  v_fma_f32 v141, v45, v45, s68
  v_mfma_f32_16x16x32_bf16 v[114:117], v[148:151], v[94:97], v[114:117]
  v_mul_f32 v138, v138, v42
  v_mul_f32 v139, v139, v43
  v_mfma_f32_16x16x32_bf16 v[110:113], v[172:175], v[98:101], v[110:113]
  v_mul_f32 v140, v140, v44
  v_mul_f32 v141, v141, v45
  v_mfma_f32_16x16x32_bf16 v[114:117], v[176:179], v[98:101], v[114:117]
  s_waitcnt lgkmcnt(0)
  v_exp_f32_e64 v138, -v138
  v_mfma_f32_16x16x32_bf16 v[110:113], v[200:203], v[102:105], v[110:113]
  v_exp_f32_e64 v139, -v139
  v_mfma_f32_16x16x32_bf16 v[114:117], v[204:207], v[102:105], v[114:117]
  s_waitcnt vmcnt(0)
  v_cmp_ne_u32 vcc, s4, v18
  v_fma_f32 v134, v46, v46, s68
  v_mfma_f32_16x16x32_bf16 v[110:113], v[228:231], v[106:109], v[110:113]
  s_cbranch_vccnz L_spin7
L_done7:
  v_exp_f32_e64 v140, -v140
  v_mfma_f32_16x16x32_bf16 v[114:117], v[232:235], v[106:109], v[114:117]
  buffer_load_dwordx4 v58, s[32:35], s74 offen offset:0 sc1 lds
  v_exp_f32_e64 v141, -v141
  v_mfma_f32_16x16x32_bf16 v[118:121], a[176:179], v[82:85], 0
  v_add_f32 v138, 1.0, v138
  v_add_f32 v139, 1.0, v139
  v_mfma_f32_16x16x32_bf16 v[122:125], a[180:183], v[82:85], 0
  buffer_load_dwordx4 v58, s[32:35], s74 offen offset:1024 sc1 lds
  v_add_f32 v140, 1.0, v140
  v_add_f32 v141, 1.0, v141
  v_mfma_f32_16x16x32_bf16 v[118:121], a[204:207], v[86:89], v[118:121]
  v_cvt_pk_bf16_f32 v126, v110, v111
  v_cvt_pk_bf16_f32 v127, v112, v113
  v_mfma_f32_16x16x32_bf16 v[122:125], a[208:211], v[86:89], v[122:125]
  buffer_load_dwordx4 v58, s[32:35], s74 offen offset:2048 sc1 lds
  v_cvt_pk_bf16_f32 v128, v114, v115
  v_cvt_pk_bf16_f32 v129, v116, v117
  v_mfma_f32_16x16x32_bf16 v[118:121], a[232:235], v[90:93], v[118:121]
  buffer_store_dwordx4 v[126:129], v9, s[32:35], s59 offen offset:0
  v_rcp_f32 v138, v138
  v_mfma_f32_16x16x32_bf16 v[122:125], a[236:239], v[90:93], v[122:125]
  buffer_load_dwordx4 v58, s[32:35], s74 offen offset:3072 sc1 lds
  v_rcp_f32 v139, v139
  v_mfma_f32_16x16x32_bf16 v[118:121], v[152:155], v[94:97], v[118:121]
  s_add_u32 m0, m0, 4096
  v_rcp_f32 v140, v140
  v_mfma_f32_16x16x32_bf16 v[122:125], v[156:159], v[94:97], v[122:125]
  buffer_load_dwordx4 v58, s[32:35], s6 offen offset:0 sc1 lds
  v_rcp_f32 v141, v141
  v_mfma_f32_16x16x32_bf16 v[118:121], v[180:183], v[98:101], v[118:121]
  v_mul_f32 v138, v138, v42
  v_mul_f32 v139, v139, v43
  v_mfma_f32_16x16x32_bf16 v[122:125], v[184:187], v[98:101], v[122:125]
  buffer_load_dwordx4 v58, s[32:35], s6 offen offset:1024 sc1 lds
  v_mul_f32 v140, v140, v44
  v_mul_f32 v141, v141, v45
  v_mfma_f32_16x16x32_bf16 v[118:121], v[208:211], v[102:105], v[118:121]
  v_cvt_pk_bf16_f32 v142, v138, v139
  v_cvt_pk_bf16_f32 v143, v140, v141
  v_mfma_f32_16x16x32_bf16 v[122:125], v[212:215], v[102:105], v[122:125]
  buffer_load_dwordx4 v58, s[32:35], s6 offen offset:2048 sc1 lds
  v_fma_f32 v135, v47, v47, s68
  v_fma_f32 v136, v48, v48, s68
  v_mfma_f32_16x16x32_bf16 v[118:121], v[236:239], v[106:109], v[118:121]
  v_fma_f32 v137, v49, v49, s68
  v_mul_f32 v134, v134, v46
  v_mfma_f32_16x16x32_bf16 v[122:125], v[240:243], v[106:109], v[122:125]
  buffer_load_dwordx4 v58, s[32:35], s6 offen offset:3072 sc1 lds
  v_mul_f32 v135, v135, v47
  v_mul_f32 v136, v136, v48
  v_mfma_f32_16x16x32_bf16 v[110:113], a[184:187], v[82:85], 0
  v_mul_f32 v137, v137, v49
  v_fma_f32 v138, v50, v50, s68
  v_mfma_f32_16x16x32_bf16 v[114:117], a[188:191], v[82:85], 0
  ds_read_b128 v[18:21], v15 offset:0
  v_fma_f32 v139, v51, v51, s68
  v_mfma_f32_16x16x32_bf16 v[110:113], a[212:215], v[86:89], v[110:113]
  v_cvt_pk_bf16_f32 v130, v118, v119
  v_cvt_pk_bf16_f32 v131, v120, v121
  v_mfma_f32_16x16x32_bf16 v[114:117], a[216:219], v[86:89], v[114:117]
  ds_read_b128 v[22:25], v15 offset:4096
  v_cvt_pk_bf16_f32 v132, v122, v123
  v_cvt_pk_bf16_f32 v133, v124, v125
  v_mfma_f32_16x16x32_bf16 v[110:113], a[240:243], v[90:93], v[110:113]
  buffer_store_dwordx4 v[130:133], v9, s[32:35], s59 offen offset:128
  v_exp_f32_e64 v134, -v134
  v_mfma_f32_16x16x32_bf16 v[114:117], a[244:247], v[90:93], v[114:117]
  ds_read_b128 v[62:65], v15 offset:40960
  v_fma_f32 v140, v52, v52, s68
  v_mfma_f32_16x16x32_bf16 v[110:113], v[160:163], v[94:97], v[110:113]
  v_exp_f32_e64 v135, -v135
  v_mfma_f32_16x16x32_bf16 v[114:117], v[164:167], v[94:97], v[114:117]
  ds_read_b128 v[26:29], v15 offset:16384
  v_fma_f32 v141, v53, v53, s68
  v_mfma_f32_16x16x32_bf16 v[110:113], v[188:191], v[98:101], v[110:113]
  v_exp_f32_e64 v136, -v136
  v_mfma_f32_16x16x32_bf16 v[114:117], v[192:195], v[98:101], v[114:117]
  ds_read_b128 v[30:33], v15 offset:20480
  v_mul_f32 v138, v138, v50
  v_exp_f32_e64 v137, -v137
  v_add_f32 v134, 1.0, v134
L_hop1:
  s_cbranch_execz L_hopret
  v_add_f32 v135, 1.0, v135
  v_add_f32 v136, 1.0, v136
  v_add_f32 v137, 1.0, v137
  v_rcp_f32 v134, v134
  v_rcp_f32 v135, v135
  v_rcp_f32 v136, v136
  v_rcp_f32 v137, v137
  v_mul_f32 v134, v134, v46
  v_mul_f32 v135, v135, v47
  v_mul_f32 v136, v136, v48
  v_mul_f32 v137, v137, v49
  v_cvt_pk_bf16_f32 v144, v134, v135
  v_cvt_pk_bf16_f32 v145, v136, v137
  ds_write_b128 v5, v[142:145] offset:21504
  v_mul_f32 v139, v139, v51
  v_mul_f32 v140, v140, v52
  v_mul_f32 v141, v141, v53
  v_exp_f32_e64 v138, -v138
  v_exp_f32_e64 v139, -v139
  v_exp_f32_e64 v140, -v140
  v_exp_f32_e64 v141, -v141
  v_add_f32 v138, 1.0, v138
  v_add_f32 v139, 1.0, v139
  v_add_f32 v140, 1.0, v140
  v_add_f32 v141, 1.0, v141
  v_rcp_f32 v138, v138
  v_rcp_f32 v139, v139
  v_rcp_f32 v140, v140
  v_rcp_f32 v141, v141
  v_mul_f32 v138, v138, v50
  v_mul_f32 v139, v139, v51
  v_mul_f32 v140, v140, v52
  v_mul_f32 v141, v141, v53
  v_cvt_pk_bf16_f32 v146, v138, v139
  v_cvt_pk_bf16_f32 v147, v140, v141
  ds_write_b64 v6, v[146:147] offset:21504
  v_mfma_f32_16x16x32_bf16 v[110:113], v[216:219], v[102:105], v[110:113]
  v_mfma_f32_16x16x32_bf16 v[114:117], v[220:223], v[102:105], v[114:117]
  ds_read_b128 v[34:37], v15 offset:8192
  v_mfma_f32_16x16x32_bf16 v[110:113], v[244:247], v[106:109], v[110:113]
  v_mfma_f32_16x16x32_bf16 v[114:117], v[248:251], v[106:109], v[114:117]
  s_waitcnt lgkmcnt(1)
  s_barrier
  ds_read_b128 v[38:41], v15 offset:12288
  v_mfma_f32_16x16x32_bf16 v[118:121], a[192:195], v[82:85], 0
  s_mul_i32 s5, s82, 2097152
  ds_read_b128 v[82:85], v4 offset:21504
  s_nop 0
  v_mfma_f32_16x16x32_bf16 v[118:121], a[220:223], v[86:89], v[118:121]
  s_add_u32 s73, s73, s5
  ds_read_b128 v[86:89], v4 offset:22528
  v_cvt_pk_bf16_f32 v126, v110, v111
  v_cvt_pk_bf16_f32 v127, v112, v113
  v_mfma_f32_16x16x32_bf16 v[118:121], a[248:251], v[90:93], v[118:121]
  s_add_u32 s75, s75, s5
  ds_read_b128 v[90:93], v4 offset:23552
  v_cvt_pk_bf16_f32 v128, v114, v115
  v_cvt_pk_bf16_f32 v129, v116, v117
  v_mfma_f32_16x16x32_bf16 v[118:121], v[168:171], v[94:97], v[118:121]
  buffer_store_dwordx4 v[126:129], v9, s[32:35], s59 offen offset:256
  ds_read_b128 v[94:97], v4 offset:24576
  v_mfma_f32_16x16x32_bf16 v[118:121], v[196:199], v[98:101], v[118:121]
  s_add_u32 s77, s77, s5
  ds_read_b128 v[98:101], v4 offset:25600
  v_mfma_f32_16x16x32_bf16 v[118:121], v[224:227], v[102:105], v[118:121]
  ds_read_b128 v[102:105], v4 offset:26624
  v_mfma_f32_16x16x32_bf16 v[118:121], v[252:255], v[106:109], v[118:121]
  s_waitcnt lgkmcnt(4)
  ds_read_b128 v[106:109], v4 offset:27648
  s_nop 0
  v_mfma_f32_16x16x32_bf16 v[110:113], a[168:171], v[82:85], 0
  s_nop 2
  v_mfma_f32_16x16x32_bf16 v[114:117], a[172:175], v[82:85], 0
  s_nop 2
  v_mfma_f32_16x16x32_bf16 v[110:113], a[196:199], v[86:89], v[110:113]
  v_cvt_pk_bf16_f32 v130, v118, v119
  v_cvt_pk_bf16_f32 v131, v120, v121
  v_mfma_f32_16x16x32_bf16 v[114:117], a[200:203], v[86:89], v[114:117]
  s_waitcnt lgkmcnt(2)
  v_mfma_f32_16x16x32_bf16 v[110:113], a[224:227], v[90:93], v[110:113]
  v_permlane16_swap_b32 v130, v132
  v_mfma_f32_16x16x32_bf16 v[114:117], a[228:231], v[90:93], v[114:117]
  v_mfma_f32_16x16x32_bf16 v[110:113], a[252:255], v[94:97], v[110:113]
  v_permlane16_swap_b32 v131, v133
  v_mfma_f32_16x16x32_bf16 v[114:117], v[148:151], v[94:97], v[114:117]
  buffer_store_dwordx4 v[130:133], v10, s[32:35], s59 offen offset:0
  v_mfma_f32_16x16x32_bf16 v[110:113], v[172:175], v[98:101], v[110:113]
  v_mfma_f32_16x16x32_bf16 v[114:117], v[176:179], v[98:101], v[114:117]
  s_waitcnt lgkmcnt(0)
  v_mfma_f32_16x16x32_bf16 v[110:113], v[200:203], v[102:105], v[110:113]
  v_mfma_f32_16x16x32_bf16 v[114:117], v[204:207], v[102:105], v[114:117]
  v_mfma_f32_16x16x32_bf16 v[110:113], v[228:231], v[106:109], v[110:113]
  v_mfma_f32_16x16x32_bf16 v[114:117], v[232:235], v[106:109], v[114:117]
  s_nop 2
  v_mfma_f32_16x16x32_bf16 v[118:121], a[176:179], v[82:85], 0
  s_nop 2
  v_mfma_f32_16x16x32_bf16 v[122:125], a[180:183], v[82:85], 0
  s_nop 2
  v_mfma_f32_16x16x32_bf16 v[118:121], a[204:207], v[86:89], v[118:121]
  v_cvt_pk_bf16_f32 v126, v110, v111
  v_cvt_pk_bf16_f32 v127, v112, v113
  v_mfma_f32_16x16x32_bf16 v[122:125], a[208:211], v[86:89], v[122:125]
  v_cvt_pk_bf16_f32 v128, v114, v115
  v_cvt_pk_bf16_f32 v129, v116, v117
  v_mfma_f32_16x16x32_bf16 v[118:121], a[232:235], v[90:93], v[118:121]
  buffer_store_dwordx4 v[126:129], v9, s[32:35], s60 offen offset:0 sc1
  v_mfma_f32_16x16x32_bf16 v[122:125], a[236:239], v[90:93], v[122:125]
  v_mfma_f32_16x16x32_bf16 v[118:121], v[152:155], v[94:97], v[118:121]
  v_mfma_f32_16x16x32_bf16 v[122:125], v[156:159], v[94:97], v[122:125]
  v_bfe_i32 v61, v11, 30, 1
  v_mfma_f32_16x16x32_bf16 v[118:121], v[180:183], v[98:101], v[118:121]
  v_and_b32 v61, 0x380, v61
  v_mfma_f32_16x16x32_bf16 v[122:125], v[184:187], v[98:101], v[122:125]
  v_and_b32 v59, 0x7fff, v11
  v_mfma_f32_16x16x32_bf16 v[118:121], v[208:211], v[102:105], v[118:121]
  v_or_b32 v59, v59, v61
  v_mfma_f32_16x16x32_bf16 v[122:125], v[212:215], v[102:105], v[122:125]
  v_lshrrev_b32 v61, 2, v59
  v_mfma_f32_16x16x32_bf16 v[118:121], v[236:239], v[106:109], v[118:121]
  v_and_b32 v61, 64, v61
  v_mfma_f32_16x16x32_bf16 v[122:125], v[240:243], v[106:109], v[122:125]
  v_xor_b32 v59, v59, v61
  s_nop 0
  v_mfma_f32_16x16x32_bf16 v[110:113], a[184:187], v[82:85], 0
  v_add_u32 v59, 106496, v59
  s_nop 0
  v_mfma_f32_16x16x32_bf16 v[114:117], a[188:191], v[82:85], 0
  v_cmp_le_u32 vcc, 131072, v59
  s_nop 0
  v_mfma_f32_16x16x32_bf16 v[110:113], a[212:215], v[86:89], v[110:113]
  v_cvt_pk_bf16_f32 v130, v118, v119
  v_cvt_pk_bf16_f32 v131, v120, v121
  v_add_u32 v61, 32768, v59
  v_mfma_f32_16x16x32_bf16 v[114:117], a[216:219], v[86:89], v[114:117]
  v_cvt_pk_bf16_f32 v132, v122, v123
  v_cvt_pk_bf16_f32 v133, v124, v125
  v_add_u32 v60, 4294914048, v59
  v_mfma_f32_16x16x32_bf16 v[110:113], a[240:243], v[90:93], v[110:113]
  buffer_store_dwordx4 v[130:133], v9, s[32:35], s60 offen offset:128 sc1
  v_cndmask_b32 v60, v61, v60, vcc
  v_mfma_f32_16x16x32_bf16 v[114:117], a[244:247], v[90:93], v[114:117]
  v_mfma_f32_16x16x32_bf16 v[110:113], v[160:163], v[94:97], v[110:113]
  v_mfma_f32_16x16x32_bf16 v[114:117], v[164:167], v[94:97], v[114:117]
  v_mfma_f32_16x16x32_bf16 v[110:113], v[188:191], v[98:101], v[110:113]
  v_mfma_f32_16x16x32_bf16 v[114:117], v[192:195], v[98:101], v[114:117]
  v_mfma_f32_16x16x32_bf16 v[110:113], v[216:219], v[102:105], v[110:113]
  v_mfma_f32_16x16x32_bf16 v[114:117], v[220:223], v[102:105], v[114:117]
  v_mfma_f32_16x16x32_bf16 v[110:113], v[244:247], v[106:109], v[110:113]
  v_mfma_f32_16x16x32_bf16 v[114:117], v[248:251], v[106:109], v[114:117]
  s_nop 2
  v_mfma_f32_16x16x32_bf16 v[118:121], a[192:195], v[82:85], 0
  s_nop 2
  v_mfma_f32_16x16x32_bf16 v[118:121], a[220:223], v[86:89], v[118:121]
  v_cvt_pk_bf16_f32 v126, v110, v111
  v_cvt_pk_bf16_f32 v127, v112, v113
  v_mfma_f32_16x16x32_bf16 v[118:121], a[248:251], v[90:93], v[118:121]
  v_cvt_pk_bf16_f32 v128, v114, v115
  v_cvt_pk_bf16_f32 v129, v116, v117
  v_mfma_f32_16x16x32_bf16 v[118:121], v[168:171], v[94:97], v[118:121]
  buffer_store_dwordx4 v[126:129], v9, s[32:35], s60 offen offset:256 sc1
  v_mfma_f32_16x16x32_bf16 v[118:121], v[196:199], v[98:101], v[118:121]
  v_mfma_f32_16x16x32_bf16 v[118:121], v[224:227], v[102:105], v[118:121]
  v_mfma_f32_16x16x32_bf16 v[118:121], v[252:255], v[106:109], v[118:121]
  s_nop 2
  s_nop 4
  v_cvt_pk_bf16_f32 v130, v118, v119
  v_cvt_pk_bf16_f32 v131, v120, v121
  s_nop 0
  v_permlane16_swap_b32 v130, v132
  v_permlane16_swap_b32 v131, v133
  buffer_store_dwordx4 v[130:133], v10, s[32:35], s60 offen offset:0 sc1
  s_waitcnt vmcnt(7)
  s_barrier
  ds_read_b128 v[66:69], v59 offset:0
  ds_read_b128 v[70:73], v59 offset:1024
  ds_read_b128 v[74:77], v59 offset:2048
  ds_read_b128 v[78:81], v59 offset:3072
  ds_read_b128 v[82:85], v59 offset:4096
  ds_read_b128 v[86:89], v59 offset:5120
  ds_read_b128 v[90:93], v59 offset:6144
  ds_read_b128 v[94:97], v59 offset:7168
  s_waitcnt lgkmcnt(7)
  v_mfma_f32_16x16x32_bf16 v[18:21], v[62:65], v[66:69], v[18:21]
  s_waitcnt lgkmcnt(6)
  v_mfma_f32_16x16x32_bf16 v[22:25], v[62:65], v[70:73], v[22:25]
  s_waitcnt lgkmcnt(5)
  v_mfma_f32_16x16x32_bf16 v[18:21], v[62:65], v[74:77], v[18:21]
  s_waitcnt lgkmcnt(4)
  v_mfma_f32_16x16x32_bf16 v[22:25], v[62:65], v[78:81], v[22:25]
  s_waitcnt lgkmcnt(3)
  v_mfma_f32_16x16x32_bf16 v[18:21], v[62:65], v[82:85], v[18:21]
  s_waitcnt lgkmcnt(2)
  v_mfma_f32_16x16x32_bf16 v[22:25], v[62:65], v[86:89], v[22:25]
  s_waitcnt lgkmcnt(1)
  v_mfma_f32_16x16x32_bf16 v[18:21], v[62:65], v[90:93], v[18:21]
  s_waitcnt lgkmcnt(0)
  v_mfma_f32_16x16x32_bf16 v[22:25], v[62:65], v[94:97], v[22:25]
  s_nop 5
  v_pk_add_f32 v[134:135], v[18:19], v[20:21]
  v_pk_mul_f32 v[136:137], v[18:19], v[18:19]
  v_pk_add_f32 v[138:139], v[22:23], v[24:25]
  v_pk_mul_f32 v[140:141], v[22:23], v[22:23]
  v_pk_fma_f32 v[136:137], v[20:21], v[20:21], v[136:137]
  v_pk_fma_f32 v[140:141], v[24:25], v[24:25], v[140:141]
  v_pk_add_f32 v[134:135], v[134:135], v[138:139]
  v_pk_add_f32 v[136:137], v[136:137], v[140:141]
  v_add_f32 v134, v134, v135
  v_add_f32 v136, v136, v137
  s_nop 1
  v_permlane32_swap_b32 v134, v136
  v_add_f32 v134, v134, v136
  v_mov_b32 v135, v134
  s_nop 1
  v_permlane16_swap_b32 v134, v135
  v_add_f32 v134, v134, v135
  s_nop 1
  v_add_f32_dpp v134, v134, v134 row_ror:8 row_mask:0xf bank_mask:0xf
  s_nop 1
  v_add_f32_dpp v134, v134, v134 row_ror:4 row_mask:0xf bank_mask:0xf
  s_nop 1
  v_add_f32_dpp v134, v134, v134 row_ror:2 row_mask:0xf bank_mask:0xf
  s_nop 1
  v_add_f32_dpp v134, v134, v134 row_ror:1 row_mask:0xf bank_mask:0xf
  v_mul_f32 v135, 0x3b124925, v134
  v_mul_f32 v138, 0x3b124925, v134
  s_nop 1
  v_permlane32_swap_b32 v135, v138
  v_fma_f32 v138, -v135, v135, v138
  v_max_f32 v138, 0, v138
  v_add_f32 v136, 0x361367a4, v138
  v_rsq_f32 v134, v136
  s_nop 0
  v_mul_f32 v134, s83, v134
  v_mul_f32_e64 v135, -v135, v134
  v_pk_fma_f32 v[66:67], v[18:19], v[134:135], v[134:135] op_sel:[0,0,1] op_sel_hi:[1,0,1]
  v_pk_fma_f32 v[68:69], v[20:21], v[134:135], v[134:135] op_sel:[0,0,1] op_sel_hi:[1,0,1]
  v_pk_fma_f32 v[70:71], v[22:23], v[134:135], v[134:135] op_sel:[0,0,1] op_sel_hi:[1,0,1]
  v_pk_fma_f32 v[72:73], v[24:25], v[134:135], v[134:135] op_sel:[0,0,1] op_sel_hi:[1,0,1]
  v_pk_fma_f32 v[18:19], v[66:67], v[26:27], v[18:19]
  v_pk_fma_f32 v[20:21], v[68:69], v[28:29], v[20:21]
  v_pk_fma_f32 v[22:23], v[70:71], v[30:31], v[22:23]
  v_pk_fma_f32 v[24:25], v[72:73], v[32:33], v[24:25]
  v_pk_add_f32 v[134:135], v[18:19], v[20:21]
  v_pk_mul_f32 v[136:137], v[18:19], v[18:19]
  v_pk_add_f32 v[138:139], v[22:23], v[24:25]
  v_pk_mul_f32 v[140:141], v[22:23], v[22:23]
  v_pk_fma_f32 v[136:137], v[20:21], v[20:21], v[136:137]
  v_pk_fma_f32 v[140:141], v[24:25], v[24:25], v[140:141]
  v_pk_add_f32 v[134:135], v[134:135], v[138:139]
  v_pk_add_f32 v[136:137], v[136:137], v[140:141]
  v_add_f32 v134, v134, v135
  v_add_f32 v136, v136, v137
  s_nop 1
  v_permlane32_swap_b32 v134, v136
  v_add_f32 v134, v134, v136
  v_mov_b32 v135, v134
  s_nop 1
  v_permlane16_swap_b32 v134, v135
  v_add_f32 v134, v134, v135
  s_nop 1
  v_add_f32_dpp v134, v134, v134 row_ror:8 row_mask:0xf bank_mask:0xf
  s_nop 1
  v_add_f32_dpp v134, v134, v134 row_ror:4 row_mask:0xf bank_mask:0xf
  s_nop 1
  v_add_f32_dpp v134, v134, v134 row_ror:2 row_mask:0xf bank_mask:0xf
  s_nop 1
  v_add_f32_dpp v134, v134, v134 row_ror:1 row_mask:0xf bank_mask:0xf
  v_mul_f32 v135, 0x3b124925, v134
  v_mul_f32 v138, 0x3b124925, v134
  s_nop 1
  v_permlane32_swap_b32 v135, v138
  v_fma_f32 v138, -v135, v135, v138
  v_max_f32 v138, 0, v138
  v_add_f32 v136, 0x361367a4, v138
  v_rsq_f32 v134, v136
  s_nop 0
  v_mul_f32 v136, v134, v134
  v_fmaak_f32 v136, v136, v138, 0x3727c5ac
  v_rsq_f32 v136, v136
  v_mul_f32 v134, s83, v134
  v_mul_f32 v134, v134, v136
  v_mul_f32_e64 v135, -v135, v134
  v_pk_fma_f32 v[66:67], v[18:19], v[134:135], v[134:135] op_sel:[0,0,1] op_sel_hi:[1,0,1]
  v_pk_fma_f32 v[68:69], v[20:21], v[134:135], v[134:135] op_sel:[0,0,1] op_sel_hi:[1,0,1]
  v_pk_fma_f32 v[70:71], v[22:23], v[134:135], v[134:135] op_sel:[0,0,1] op_sel_hi:[1,0,1]
  v_pk_fma_f32 v[72:73], v[24:25], v[134:135], v[134:135] op_sel:[0,0,1] op_sel_hi:[1,0,1]
  v_cvt_pk_bf16_f32 v50, v66, v67
  v_cvt_pk_bf16_f32 v52, v70, v71
  v_cvt_pk_bf16_f32 v51, v68, v69
  v_cvt_pk_bf16_f32 v53, v72, v73
  v_permlane16_swap_b32 v50, v52
  s_nop 0
  v_permlane16_swap_b32 v51, v53
  buffer_store_dwordx4 v[50:53], v14, s[32:35], s73 offen
  s_waitcnt vmcnt(1)
  s_cmp_lg_u32 s82, 0
  s_cbranch_scc1 L_far8
  buffer_store_dword v12, v2, s[32:35], s64 offen offset:384
L_near8:
  ds_write_b128 v15, v[18:21] offset:0
  ds_write_b128 v15, v[22:25] offset:4096
  ds_read_b128 v[26:29], v15 offset:24576
  ds_read_b128 v[30:33], v15 offset:28672
  ds_read_b128 v[42:45], v8 offset:0
  ds_read_b128 v[46:49], v8 offset:64
  ds_read_b128 v[50:53], v8 offset:128
  s_waitcnt vmcnt(1)
  s_cmp_lg_u32 s82, 0
  s_cbranch_scc1 L_far9
  buffer_store_dword v12, v2, s[32:35], s64 offen offset:512
L_near9:
  buffer_load_dword v126, v1, s[32:35], s76 offen offset:384 sc1
  s_waitcnt vmcnt(0)
  v_cmp_ne_u32 vcc, s4, v126
  s_cbranch_vccnz L_spin10
L_done10:
  buffer_load_dword v127, v1, s[32:35], s76 offen offset:512 sc1
  s_add_u32 s6, s74, 32768
  s_add_u32 s7, s74, 36864
  s_mov_b32 m0, s62
  s_nop 0
  buffer_load_dwordx4 v58, s[32:35], s6 offen offset:0 sc1 lds
  buffer_load_dwordx4 v58, s[32:35], s6 offen offset:1024 sc1 lds
  buffer_load_dwordx4 v58, s[32:35], s6 offen offset:2048 sc1 lds
  buffer_load_dwordx4 v58, s[32:35], s6 offen offset:3072 sc1 lds
  s_add_u32 m0, m0, 4096
  s_nop 0
  buffer_load_dwordx4 v58, s[32:35], s7 offen offset:0 sc1 lds
  buffer_load_dwordx4 v58, s[32:35], s7 offen offset:1024 sc1 lds
  buffer_load_dwordx4 v58, s[32:35], s7 offen offset:2048 sc1 lds
  buffer_load_dwordx4 v58, s[32:35], s7 offen offset:3072 sc1 lds
  s_mul_i32 s5, s82, 16777216
  s_add_u32 s74, s74, s5
  s_add_u32 s58, s58, s5
  s_add_u32 s59, s59, s5
  s_add_u32 s60, s60, s5
  s_waitcnt vmcnt(8)
  v_cmp_ne_u32 vcc, s4, v127
  s_cbranch_vccnz L_spin11
L_done11:
  s_lshl_b32 s5, s3, 10
  s_add_u32 m0, s5, 106496
  s_mov_b32 s6, s73
  buffer_load_dwordx4 v13, s[32:35], s6 offen sc1 lds
  s_add_u32 m0, m0, 4096
  s_add_u32 s6, s6, 4096
  buffer_load_dwordx4 v13, s[32:35], s6 offen sc1 lds
  s_add_u32 m0, m0, 4096
  s_add_u32 s6, s6, 4096
  buffer_load_dwordx4 v13, s[32:35], s6 offen sc1 lds
  s_add_u32 m0, m0, 4096
  s_add_u32 s6, s6, 4096
  buffer_load_dwordx4 v13, s[32:35], s6 offen sc1 lds
  s_add_u32 m0, m0, 4096
  s_add_u32 s6, s6, 4096
  buffer_load_dwordx4 v13, s[32:35], s6 offen sc1 lds
  s_add_u32 m0, m0, 4096
  s_add_u32 s6, s6, 4096
  buffer_load_dwordx4 v13, s[32:35], s6 offen sc1 lds
  s_add_u32 m0, m0, 4096
  s_add_u32 s6, s6, 4096
  buffer_load_dwordx4 v13, s[32:35], s6 offen sc1 lds
  s_waitcnt vmcnt(7)
  s_barrier
  ds_read_b128 v[66:69], v60 offset:0
  ds_read_b128 v[70:73], v60 offset:1024
  ds_read_b128 v[74:77], v60 offset:2048
  ds_read_b128 v[78:81], v60 offset:3072
  ds_read_b128 v[82:85], v60 offset:4096
  ds_read_b128 v[86:89], v60 offset:5120
  ds_read_b128 v[90:93], v60 offset:6144
  ds_read_b128 v[94:97], v60 offset:7168
  s_waitcnt lgkmcnt(7)
  v_mfma_f32_16x16x32_bf16 v[34:37], v[62:65], v[66:69], v[34:37]
  s_waitcnt lgkmcnt(6)
  v_mfma_f32_16x16x32_bf16 v[38:41], v[62:65], v[70:73], v[38:41]
  s_waitcnt lgkmcnt(5)
  v_mfma_f32_16x16x32_bf16 v[34:37], v[62:65], v[74:77], v[34:37]
  s_waitcnt lgkmcnt(4)
  v_mfma_f32_16x16x32_bf16 v[38:41], v[62:65], v[78:81], v[38:41]
  s_waitcnt lgkmcnt(3)
  v_mfma_f32_16x16x32_bf16 v[34:37], v[62:65], v[82:85], v[34:37]
  s_waitcnt lgkmcnt(2)
  v_mfma_f32_16x16x32_bf16 v[38:41], v[62:65], v[86:89], v[38:41]
  s_waitcnt lgkmcnt(1)
  v_mfma_f32_16x16x32_bf16 v[34:37], v[62:65], v[90:93], v[34:37]
  s_waitcnt lgkmcnt(0)
  v_mfma_f32_16x16x32_bf16 v[38:41], v[62:65], v[94:97], v[38:41]
  s_nop 5
  v_pk_add_f32 v[134:135], v[34:35], v[36:37]
  v_pk_mul_f32 v[136:137], v[34:35], v[34:35]
  v_pk_add_f32 v[138:139], v[38:39], v[40:41]
  v_pk_mul_f32 v[140:141], v[38:39], v[38:39]
  v_pk_fma_f32 v[136:137], v[36:37], v[36:37], v[136:137]
  v_pk_fma_f32 v[140:141], v[40:41], v[40:41], v[140:141]
  v_pk_add_f32 v[134:135], v[134:135], v[138:139]
  v_pk_add_f32 v[136:137], v[136:137], v[140:141]
  v_add_f32 v134, v134, v135
  v_add_f32 v136, v136, v137
  s_nop 1
  v_permlane32_swap_b32 v134, v136
  v_add_f32 v134, v134, v136
  v_mov_b32 v135, v134
  s_nop 1
  v_permlane16_swap_b32 v134, v135
  v_add_f32 v134, v134, v135
  s_nop 1
  v_add_f32_dpp v134, v134, v134 row_ror:8 row_mask:0xf bank_mask:0xf
  s_nop 1
  v_add_f32_dpp v134, v134, v134 row_ror:4 row_mask:0xf bank_mask:0xf
  s_nop 1
  v_add_f32_dpp v134, v134, v134 row_ror:2 row_mask:0xf bank_mask:0xf
  s_nop 1
  v_add_f32_dpp v134, v134, v134 row_ror:1 row_mask:0xf bank_mask:0xf
  v_mul_f32 v135, 0x3b124925, v134
  v_mul_f32 v138, 0x3b124925, v134
  s_nop 1
  v_permlane32_swap_b32 v135, v138
  v_fma_f32 v138, -v135, v135, v138
  v_max_f32 v138, 0, v138
  v_add_f32 v136, 0x361367a4, v138
  v_rsq_f32 v134, v136
  s_nop 0
  v_mul_f32 v134, s83, v134
  v_mul_f32_e64 v135, -v135, v134
  v_pk_fma_f32 v[98:99], v[34:35], v[134:135], v[134:135] op_sel:[0,0,1] op_sel_hi:[1,0,1]
  v_pk_fma_f32 v[100:101], v[36:37], v[134:135], v[134:135] op_sel:[0,0,1] op_sel_hi:[1,0,1]
  v_pk_fma_f32 v[102:103], v[38:39], v[134:135], v[134:135] op_sel:[0,0,1] op_sel_hi:[1,0,1]
  v_pk_fma_f32 v[104:105], v[40:41], v[134:135], v[134:135] op_sel:[0,0,1] op_sel_hi:[1,0,1]
  v_pk_fma_f32 v[34:35], v[98:99], v[26:27], v[34:35]
  v_pk_fma_f32 v[36:37], v[100:101], v[28:29], v[36:37]
  v_pk_fma_f32 v[38:39], v[102:103], v[30:31], v[38:39]
  v_pk_fma_f32 v[40:41], v[104:105], v[32:33], v[40:41]
  v_pk_add_f32 v[134:135], v[34:35], v[36:37]
  v_pk_mul_f32 v[136:137], v[34:35], v[34:35]
  v_pk_add_f32 v[138:139], v[38:39], v[40:41]
  v_pk_mul_f32 v[140:141], v[38:39], v[38:39]
  v_pk_fma_f32 v[136:137], v[36:37], v[36:37], v[136:137]
  v_pk_fma_f32 v[140:141], v[40:41], v[40:41], v[140:141]
  v_pk_add_f32 v[134:135], v[134:135], v[138:139]
  v_pk_add_f32 v[136:137], v[136:137], v[140:141]
  v_add_f32 v134, v134, v135
  v_add_f32 v136, v136, v137
  s_nop 1
  v_permlane32_swap_b32 v134, v136
  v_add_f32 v134, v134, v136
  v_mov_b32 v135, v134
  s_nop 1
  v_permlane16_swap_b32 v134, v135
  v_add_f32 v134, v134, v135
  s_nop 1
  v_add_f32_dpp v134, v134, v134 row_ror:8 row_mask:0xf bank_mask:0xf
  s_nop 1
  v_add_f32_dpp v134, v134, v134 row_ror:4 row_mask:0xf bank_mask:0xf
  s_nop 1
  v_add_f32_dpp v134, v134, v134 row_ror:2 row_mask:0xf bank_mask:0xf
  s_nop 1
  v_add_f32_dpp v134, v134, v134 row_ror:1 row_mask:0xf bank_mask:0xf
  v_mul_f32 v135, 0x3b124925, v134
  v_mul_f32 v138, 0x3b124925, v134
  s_nop 1
  v_permlane32_swap_b32 v135, v138
  v_fma_f32 v138, -v135, v135, v138
  v_max_f32 v138, 0, v138
  v_add_f32 v136, 0x361367a4, v138
  v_rsq_f32 v134, v136
  s_nop 0
  v_mul_f32 v136, v134, v134
  v_fmaak_f32 v136, v136, v138, 0x3727c5ac
  v_rsq_f32 v136, v136
  v_mul_f32 v134, s83, v134
  v_mul_f32 v134, v134, v136
  v_mul_f32_e64 v135, -v135, v134
  v_pk_fma_f32 v[98:99], v[34:35], v[134:135], v[134:135] op_sel:[0,0,1] op_sel_hi:[1,0,1]
  v_pk_fma_f32 v[100:101], v[36:37], v[134:135], v[134:135] op_sel:[0,0,1] op_sel_hi:[1,0,1]
  v_pk_fma_f32 v[102:103], v[38:39], v[134:135], v[134:135] op_sel:[0,0,1] op_sel_hi:[1,0,1]
  v_pk_fma_f32 v[104:105], v[40:41], v[134:135], v[134:135] op_sel:[0,0,1] op_sel_hi:[1,0,1]
  v_cvt_pk_bf16_f32 v54, v98, v99
  v_cvt_pk_bf16_f32 v56, v102, v103
  v_cvt_pk_bf16_f32 v55, v100, v101
  v_cvt_pk_bf16_f32 v57, v104, v105
  v_permlane16_swap_b32 v54, v56
  s_nop 0
  v_permlane16_swap_b32 v55, v57
  buffer_store_dwordx4 v[54:57], v14, s[32:35], s75 offen
  ds_write_b128 v15, v[34:37] offset:8192
  ds_write_b128 v15, v[38:41] offset:12288
  s_waitcnt vmcnt(4)
  s_barrier
  ds_read_b128 v[66:69], v3 offset:0
  ds_read_b128 v[70:73], v3 offset:1024
  ds_read_b128 v[74:77], v3 offset:2048
  ds_read_b128 v[78:81], v3 offset:3072
  ds_read_b128 v[54:57], v3 offset:4096
  ds_read_b128 v[58:61], v3 offset:5120
  s_waitcnt lgkmcnt(5)
  v_mfma_f32_16x16x32_bf16 v[42:45], a[0:3], v[66:69], v[42:45]
  v_mfma_f32_16x16x32_bf16 v[46:49], a[4:7], v[66:69], v[46:49]
  v_mfma_f32_16x16x32_bf16 v[50:53], a[8:11], v[66:69], v[50:53]
  s_waitcnt lgkmcnt(4)
  ds_read_b128 v[66:69], v3 offset:6144
  v_mfma_f32_16x16x32_bf16 v[42:45], a[12:15], v[70:73], v[42:45]
  v_mfma_f32_16x16x32_bf16 v[46:49], a[16:19], v[70:73], v[46:49]
  v_mfma_f32_16x16x32_bf16 v[50:53], a[20:23], v[70:73], v[50:53]
  s_waitcnt lgkmcnt(3)
  ds_read_b128 v[70:73], v3 offset:7168
  v_mfma_f32_16x16x32_bf16 v[42:45], a[24:27], v[74:77], v[42:45]
  ds_read_b128 v[82:85], v7 offset:0
  v_mfma_f32_16x16x32_bf16 v[46:49], a[28:31], v[74:77], v[46:49]
  ds_read_b128 v[86:89], v7 offset:2048
  v_mfma_f32_16x16x32_bf16 v[50:53], a[32:35], v[74:77], v[50:53]
  ds_read_b128 v[74:77], v3 offset:8192
  v_mfma_f32_16x16x32_bf16 v[42:45], a[36:39], v[78:81], v[42:45]
  ds_read_b128 v[90:93], v7 offset:4096
  v_mfma_f32_16x16x32_bf16 v[46:49], a[40:43], v[78:81], v[46:49]
  ds_read_b128 v[94:97], v7 offset:6144
  v_mfma_f32_16x16x32_bf16 v[50:53], a[44:47], v[78:81], v[50:53]
  s_waitcnt lgkmcnt(7)
  ds_read_b128 v[78:81], v3 offset:9216
  v_mfma_f32_16x16x32_bf16 v[42:45], a[48:51], v[54:57], v[42:45]
  ds_read_b128 v[98:101], v7 offset:8192
  v_mfma_f32_16x16x32_bf16 v[46:49], a[52:55], v[54:57], v[46:49]
  ds_read_b128 v[102:105], v7 offset:10240
  v_mfma_f32_16x16x32_bf16 v[50:53], a[56:59], v[54:57], v[50:53]
  s_waitcnt vmcnt(0)
  ds_read_b128 v[54:57], v3 offset:10240
  v_mfma_f32_16x16x32_bf16 v[42:45], a[60:63], v[58:61], v[42:45]
  s_cmp_lg_u32 s82, 0
  s_cbranch_scc1 L_far12
  buffer_store_dword v12, v2, s[32:35], s64 offen offset:640
L_near12:
  ds_read_b128 v[106:109], v7 offset:12288
  v_mfma_f32_16x16x32_bf16 v[46:49], a[64:67], v[58:61], v[46:49]
  ds_read_b128 v[30:33], v7 offset:14336
  v_mfma_f32_16x16x32_bf16 v[50:53], a[68:71], v[58:61], v[50:53]
  s_waitcnt lgkmcnt(11)
  ds_read_b128 v[58:61], v3 offset:11264
  v_mfma_f32_16x16x32_bf16 v[42:45], a[72:75], v[66:69], v[42:45]
  ds_read_b128 v[34:37], v7 offset:16384
  v_mfma_f32_16x16x32_bf16 v[46:49], a[76:79], v[66:69], v[46:49]
  ds_read_b128 v[38:41], v7 offset:18432
  v_mfma_f32_16x16x32_bf16 v[50:53], a[80:83], v[66:69], v[50:53]
  ds_read_b128 v[66:69], v3 offset:12288
  v_add_u32 v62, s66, v8
  v_mfma_f32_16x16x32_bf16 v[42:45], a[84:87], v[70:73], v[42:45]
  ds_read_b128 v[62:65], v62
  v_mfma_f32_16x16x32_bf16 v[46:49], a[88:91], v[70:73], v[46:49]
  ds_read_b128 v[18:21], v8 offset:0
  v_mfma_f32_16x16x32_bf16 v[50:53], a[92:95], v[70:73], v[50:53]
  s_waitcnt lgkmcnt(11)
  ds_read_b128 v[70:73], v3 offset:13312
  v_mfma_f32_16x16x32_bf16 v[42:45], a[96:99], v[74:77], v[42:45]
  v_mfma_f32_16x16x32_bf16 v[46:49], a[100:103], v[74:77], v[46:49]
  s_barrier
  v_mfma_f32_16x16x32_bf16 v[50:53], a[104:107], v[74:77], v[50:53]
  ds_read_b128 v[74:77], v17 offset:0
  v_mfma_f32_16x16x32_bf16 v[42:45], a[108:111], v[78:81], v[42:45]
  v_mfma_f32_16x16x32_bf16 v[46:49], a[112:115], v[78:81], v[46:49]
  ds_read_b128 v[22:25], v8 offset:64
  v_mfma_f32_16x16x32_bf16 v[50:53], a[116:119], v[78:81], v[50:53]
  s_waitcnt lgkmcnt(8)
  ds_read_b128 v[78:81], v17 offset:1024
  v_mfma_f32_16x16x32_bf16 v[42:45], a[120:123], v[54:57], v[42:45]
  ds_read_b128 v[26:29], v8 offset:128
  v_mfma_f32_16x16x32_bf16 v[46:49], a[124:127], v[54:57], v[46:49]
  v_mfma_f32_16x16x32_bf16 v[50:53], a[128:131], v[54:57], v[50:53]
  ds_read_b128 v[54:57], v17 offset:2048
  v_mfma_f32_16x16x32_bf16 v[42:45], a[132:135], v[58:61], v[42:45]
  v_mfma_f32_16x16x32_bf16 v[46:49], a[136:139], v[58:61], v[46:49]
  v_mfma_f32_16x16x32_bf16 v[50:53], a[140:143], v[58:61], v[50:53]
  s_waitcnt lgkmcnt(5)
  ds_read_b128 v[58:61], v17 offset:3072
  v_mfma_f32_16x16x32_bf16 v[42:45], a[144:147], v[66:69], v[42:45]
  v_mfma_f32_16x16x32_bf16 v[46:49], a[148:151], v[66:69], v[46:49]
  v_mfma_f32_16x16x32_bf16 v[50:53], a[152:155], v[66:69], v[50:53]
  buffer_load_dword v127, v1, s[32:35], s76 offen offset:640 sc1
  ds_read_b128 v[66:69], v17 offset:4096
  v_mfma_f32_16x16x32_bf16 v[42:45], a[156:159], v[70:73], v[42:45]
  s_mov_b32 m0, s84
  v_mfma_f32_16x16x32_bf16 v[46:49], a[160:163], v[70:73], v[46:49]
  s_add_u32 s6, s77, 13824
  v_mfma_f32_16x16x32_bf16 v[50:53], a[164:167], v[70:73], v[50:53]
  s_waitcnt lgkmcnt(4)
  ds_read_b128 v[70:73], v17 offset:5120
  v_mfma_f32_16x16x32_bf16 v[62:65], v[82:85], v[74:77], v[62:65]
  ds_read_b128 v[74:77], v17 offset:6144
  ds_read_b128 v[82:85], v7 offset:20480
  v_mfma_f32_16x16x32_bf16 v[62:65], v[86:89], v[78:81], v[62:65]
  s_waitcnt lgkmcnt(4)
  ds_read_b128 v[78:81], v17 offset:7168
  ds_read_b128 v[86:89], v7 offset:22528
  v_mfma_f32_16x16x32_bf16 v[62:65], v[90:93], v[54:57], v[62:65]
  ds_read_b128 v[54:57], v17 offset:8192
  ds_read_b128 v[90:93], v7 offset:24576
  v_mfma_f32_16x16x32_bf16 v[62:65], v[94:97], v[58:61], v[62:65]
  s_waitcnt lgkmcnt(6)
  ds_read_b128 v[58:61], v17 offset:9216
  ds_read_b128 v[94:97], v7 offset:26624
  v_mfma_f32_16x16x32_bf16 v[62:65], v[98:101], v[66:69], v[62:65]
  ds_read_b128 v[66:69], v17 offset:10240
  v_fma_f32 v134, v42, v42, s68
  v_mfma_f32_16x16x32_bf16 v[62:65], v[102:105], v[70:73], v[62:65]
  s_waitcnt lgkmcnt(6)
  ds_read_b128 v[70:73], v17 offset:11264
  v_fma_f32 v135, v43, v43, s68
  v_mfma_f32_16x16x32_bf16 v[62:65], v[106:109], v[74:77], v[62:65]
  s_waitcnt vmcnt(0)
  ds_read_b128 v[74:77], v17 offset:12288
  v_cmp_ne_u32 vcc, s4, v127
  v_mfma_f32_16x16x32_bf16 v[62:65], v[30:33], v[78:81], v[62:65]
  s_waitcnt lgkmcnt(4)
  ds_read_b128 v[78:81], v17 offset:13312
  v_fma_f32 v136, v44, v44, s68
  v_mfma_f32_16x16x32_bf16 v[62:65], v[34:37], v[54:57], v[62:65]
  s_cbranch_vccnz L_spin13
L_done13:
  ds_read_b128 v[54:57], v3 offset:14336
  v_fma_f32 v137, v45, v45, s68
  v_mfma_f32_16x16x32_bf16 v[62:65], v[38:41], v[58:61], v[62:65]
  s_waitcnt lgkmcnt(3)
  ds_read_b128 v[58:61], v3 offset:15360
  v_mul_f32 v134, v134, v42
  v_mfma_f32_16x16x32_bf16 v[62:65], v[82:85], v[66:69], v[62:65]
  buffer_load_dwordx4 v13, s[32:35], s77 offen offset:0 sc1 lds
  ds_read_b128 v[66:69], v3 offset:16384
  v_mul_f32 v135, v135, v43
  v_mfma_f32_16x16x32_bf16 v[62:65], v[86:89], v[70:73], v[62:65]
  s_waitcnt lgkmcnt(3)
  ds_read_b128 v[70:73], v3 offset:17408
  v_mul_f32 v136, v136, v44
  v_mfma_f32_16x16x32_bf16 v[62:65], v[90:93], v[74:77], v[62:65]
L_hop2:
  s_cbranch_execz L_hopret
  ds_read_b128 v[74:77], v3 offset:18432
  v_mul_f32 v137, v137, v45
  v_mfma_f32_16x16x32_bf16 v[62:65], v[94:97], v[78:81], v[62:65]
  s_waitcnt lgkmcnt(3)
  ds_read_b128 v[78:81], v3 offset:19456
  v_fma_f32 v138, v46, v46, s68
  v_mfma_f32_16x16x32_bf16 v[18:21], a[0:3], v[54:57], v[18:21]
  buffer_load_dwordx4 v13, s[32:35], s77 offen offset:1024 sc1 lds
  v_exp_f32_e64 v134, -v134
  v_mfma_f32_16x16x32_bf16 v[22:25], a[4:7], v[54:57], v[22:25]
  v_exp_f32_e64 v135, -v135
  v_mfma_f32_16x16x32_bf16 v[26:29], a[8:11], v[54:57], v[26:29]
  ds_read_b128 v[54:57], v3 offset:20480
  v_fma_f32 v139, v47, v47, s68
  v_mfma_f32_16x16x32_bf16 v[18:21], a[12:15], v[58:61], v[18:21]
  buffer_load_dwordx4 v13, s[32:35], s77 offen offset:2048 sc1 lds
  ds_read_b128 v[30:33], v8 offset:0
  v_fma_f32 v140, v48, v48, s68
  v_mfma_f32_16x16x32_bf16 v[22:25], a[16:19], v[58:61], v[22:25]
  ds_read_b128 v[34:37], v8 offset:64
  v_fma_f32 v141, v49, v49, s68
  v_mfma_f32_16x16x32_bf16 v[26:29], a[20:23], v[58:61], v[26:29]
  s_waitcnt lgkmcnt(5)
  ds_read_b128 v[58:61], v3 offset:21504
  v_mul_f32 v138, v138, v46
  v_mfma_f32_16x16x32_bf16 v[18:21], a[24:27], v[66:69], v[18:21]
  buffer_load_dwordx4 v13, s[32:35], s77 offen offset:3072 sc1 lds
  ds_read_b128 v[38:41], v8 offset:128
  v_mul_f32 v139, v139, v47
  v_mfma_f32_16x16x32_bf16 v[22:25], a[28:31], v[66:69], v[22:25]
  s_add_u32 m0, m0, 13824
  v_exp_f32_e64 v136, -v136
  v_mfma_f32_16x16x32_bf16 v[26:29], a[32:35], v[66:69], v[26:29]
  ds_read_b128 v[66:69], v3 offset:22528
  v_mul_f32 v140, v140, v48
  v_mfma_f32_16x16x32_bf16 v[18:21], a[36:39], v[70:73], v[18:21]
  buffer_load_dwordx4 v13, s[32:35], s6 offen offset:0 sc1 lds
  v_exp_f32_e64 v137, -v137
  v_mfma_f32_16x16x32_bf16 v[22:25], a[40:43], v[70:73], v[22:25]
  v_add_f32 v134, 1.0, v134
  v_add_f32 v135, 1.0, v135
  v_mfma_f32_16x16x32_bf16 v[26:29], a[44:47], v[70:73], v[26:29]
  s_waitcnt lgkmcnt(6)
  ds_read_b128 v[70:73], v3 offset:23552
  v_add_f32 v136, 1.0, v136
  v_mfma_f32_16x16x32_bf16 v[18:21], a[48:51], v[74:77], v[18:21]
  buffer_load_dwordx4 v13, s[32:35], s6 offen offset:1024 sc1 lds
  v_add_f32 v137, 1.0, v137
  v_mul_f32 v141, v141, v49
  v_mfma_f32_16x16x32_bf16 v[22:25], a[52:55], v[74:77], v[22:25]
  v_rcp_f32 v134, v134
  v_mfma_f32_16x16x32_bf16 v[26:29], a[56:59], v[74:77], v[26:29]
  ds_read_b128 v[74:77], v3 offset:24576
  v_mfma_f32_16x16x32_bf16 v[18:21], a[60:63], v[78:81], v[18:21]
  buffer_load_dwordx4 v13, s[32:35], s6 offen offset:2048 sc1 lds
  v_rcp_f32 v135, v135
  v_mfma_f32_16x16x32_bf16 v[22:25], a[64:67], v[78:81], v[22:25]
  v_rcp_f32 v136, v136
  v_mfma_f32_16x16x32_bf16 v[26:29], a[68:71], v[78:81], v[26:29]
  s_waitcnt lgkmcnt(4)
  ds_read_b128 v[78:81], v3 offset:25600
  v_mfma_f32_16x16x32_bf16 v[18:21], a[72:75], v[54:57], v[18:21]
  buffer_load_dwordx4 v13, s[32:35], s6 offen offset:3072 sc1 lds
  v_rcp_f32 v137, v137
  v_mfma_f32_16x16x32_bf16 v[22:25], a[76:79], v[54:57], v[22:25]
  v_mul_f32 v134, v134, v42
  v_mul_f32 v135, v135, v43
  v_mfma_f32_16x16x32_bf16 v[26:29], a[80:83], v[54:57], v[26:29]
  ds_read_b128 v[54:57], v3 offset:26624
  v_mul_f32 v136, v136, v44
  v_mfma_f32_16x16x32_bf16 v[18:21], a[84:87], v[58:61], v[18:21]
  v_mul_f32 v137, v137, v45
  v_cvt_pk_bf16_f32 v142, v134, v135
  v_mfma_f32_16x16x32_bf16 v[22:25], a[88:91], v[58:61], v[22:25]
  v_cvt_pk_bf16_f32 v143, v136, v137
  v_fma_f32 v134, v50, v50, s68
  v_mfma_f32_16x16x32_bf16 v[26:29], a[92:95], v[58:61], v[26:29]
  s_waitcnt lgkmcnt(3)
  ds_read_b128 v[58:61], v3 offset:27648
  v_fma_f32 v135, v51, v51, s68
  v_mfma_f32_16x16x32_bf16 v[18:21], a[96:99], v[66:69], v[18:21]
  v_exp_f32_e64 v138, -v138
  v_mfma_f32_16x16x32_bf16 v[22:25], a[100:103], v[66:69], v[22:25]
  v_exp_f32_e64 v139, -v139
  v_mfma_f32_16x16x32_bf16 v[26:29], a[104:107], v[66:69], v[26:29]
  v_exp_f32_e64 v140, -v140
  v_mfma_f32_16x16x32_bf16 v[18:21], a[108:111], v[70:73], v[18:21]
  v_exp_f32_e64 v141, -v141
  v_mfma_f32_16x16x32_bf16 v[22:25], a[112:115], v[70:73], v[22:25]
  v_add_f32 v138, 1.0, v138
  v_add_f32 v139, 1.0, v139
  v_mfma_f32_16x16x32_bf16 v[26:29], a[116:119], v[70:73], v[26:29]
  s_waitcnt lgkmcnt(2)
  v_add_f32 v140, 1.0, v140
  v_add_f32 v141, 1.0, v141
  v_mfma_f32_16x16x32_bf16 v[18:21], a[120:123], v[74:77], v[18:21]
  v_rcp_f32 v138, v138
  v_mfma_f32_16x16x32_bf16 v[22:25], a[124:127], v[74:77], v[22:25]
  v_rcp_f32 v139, v139
  v_mfma_f32_16x16x32_bf16 v[26:29], a[128:131], v[74:77], v[26:29]
  s_waitcnt vmcnt(4)
  s_barrier
  v_mfma_f32_16x16x32_bf16 v[18:21], a[132:135], v[78:81], v[18:21]
  ds_read_b128 v[66:69], v3 offset:28672
  v_fma_f32 v136, v52, v52, s68
  v_mfma_f32_16x16x32_bf16 v[22:25], a[136:139], v[78:81], v[22:25]
  v_rcp_f32 v140, v140
  v_mfma_f32_16x16x32_bf16 v[26:29], a[140:143], v[78:81], v[26:29]
  s_waitcnt lgkmcnt(1)
  ds_read_b128 v[70:73], v3 offset:29696
  v_fma_f32 v137, v53, v53, s68
  v_mfma_f32_16x16x32_bf16 v[18:21], a[144:147], v[54:57], v[18:21]
  v_rcp_f32 v141, v141
  v_mfma_f32_16x16x32_bf16 v[22:25], a[148:151], v[54:57], v[22:25]
  ds_read_b128 v[74:77], v3 offset:30720
  v_mul_f32 v138, v138, v46
  v_mfma_f32_16x16x32_bf16 v[26:29], a[152:155], v[54:57], v[26:29]
  v_mul_f32 v139, v139, v47
  v_mul_f32 v140, v140, v48
  v_mfma_f32_16x16x32_bf16 v[18:21], a[156:159], v[58:61], v[18:21]
  ds_read_b128 v[78:81], v3 offset:31744
  v_mul_f32 v141, v141, v49
  v_mfma_f32_16x16x32_bf16 v[22:25], a[160:163], v[58:61], v[22:25]
  v_cvt_pk_bf16_f32 v144, v138, v139
  v_cvt_pk_bf16_f32 v145, v140, v141
  v_mfma_f32_16x16x32_bf16 v[26:29], a[164:167], v[58:61], v[26:29]
  s_waitcnt lgkmcnt(2)
  ds_read_b128 v[54:57], v3 offset:32768
  v_mul_f32 v134, v134, v50
  v_mfma_f32_16x16x32_bf16 v[30:33], a[0:3], v[66:69], v[30:33]
  v_mul_f32 v135, v135, v51
  v_mul_f32 v136, v136, v52
  v_mfma_f32_16x16x32_bf16 v[34:37], a[4:7], v[66:69], v[34:37]
  ds_read_b128 v[58:61], v3 offset:33792
  v_mul_f32 v137, v137, v53
  v_mfma_f32_16x16x32_bf16 v[38:41], a[8:11], v[66:69], v[38:41]
  ds_read_b128 v[66:69], v3 offset:34816
  v_fma_f32 v138, v62, v62, s68
  v_mfma_f32_16x16x32_bf16 v[30:33], a[12:15], v[70:73], v[30:33]
  ds_write_b128 v5, v[142:145] offset:0
  v_mfma_f32_16x16x32_bf16 v[34:37], a[16:19], v[70:73], v[34:37]
  v_exp_f32_e64 v134, -v134
  v_mfma_f32_16x16x32_bf16 v[38:41], a[20:23], v[70:73], v[38:41]
  s_waitcnt lgkmcnt(4)
  ds_read_b128 v[70:73], v3 offset:35840
  v_fma_f32 v139, v63, v63, s68
  v_mfma_f32_16x16x32_bf16 v[30:33], a[24:27], v[74:77], v[30:33]
  v_exp_f32_e64 v135, -v135
  v_mfma_f32_16x16x32_bf16 v[34:37], a[28:31], v[74:77], v[34:37]
  v_exp_f32_e64 v136, -v136
  v_mfma_f32_16x16x32_bf16 v[38:41], a[32:35], v[74:77], v[38:41]
  ds_read_b128 v[74:77], v3 offset:36864
  v_fma_f32 v140, v64, v64, s68
  v_mfma_f32_16x16x32_bf16 v[30:33], a[36:39], v[78:81], v[30:33]
  v_exp_f32_e64 v137, -v137
  v_mfma_f32_16x16x32_bf16 v[34:37], a[40:43], v[78:81], v[34:37]
  v_add_f32 v134, 1.0, v134
  v_add_f32 v135, 1.0, v135
  v_mfma_f32_16x16x32_bf16 v[38:41], a[44:47], v[78:81], v[38:41]
  s_waitcnt lgkmcnt(4)
  ds_read_b128 v[78:81], v3 offset:37888
  v_add_f32 v136, 1.0, v136
  v_mfma_f32_16x16x32_bf16 v[30:33], a[48:51], v[54:57], v[30:33]
  v_add_f32 v137, 1.0, v137
  v_fma_f32 v141, v65, v65, s68
  v_mfma_f32_16x16x32_bf16 v[34:37], a[52:55], v[54:57], v[34:37]
  v_rcp_f32 v134, v134
  v_mfma_f32_16x16x32_bf16 v[38:41], a[56:59], v[54:57], v[38:41]
  ds_read_b128 v[54:57], v3 offset:38912
  v_mul_f32 v138, v138, v62
  v_mfma_f32_16x16x32_bf16 v[30:33], a[60:63], v[58:61], v[30:33]
  v_rcp_f32 v135, v135
  v_mfma_f32_16x16x32_bf16 v[34:37], a[64:67], v[58:61], v[34:37]
  v_rcp_f32 v136, v136
  v_mfma_f32_16x16x32_bf16 v[38:41], a[68:71], v[58:61], v[38:41]
  s_waitcnt lgkmcnt(3)
  ds_read_b128 v[58:61], v3 offset:39936
  v_mul_f32 v139, v139, v63
  v_mfma_f32_16x16x32_bf16 v[30:33], a[72:75], v[66:69], v[30:33]
  v_rcp_f32 v137, v137
  v_mfma_f32_16x16x32_bf16 v[34:37], a[76:79], v[66:69], v[34:37]
  v_mul_f32 v134, v134, v50
  v_mul_f32 v135, v135, v51
  v_mfma_f32_16x16x32_bf16 v[38:41], a[80:83], v[66:69], v[38:41]
  ds_read_b128 v[66:69], v3 offset:40960
  v_mul_f32 v136, v136, v52
  v_mfma_f32_16x16x32_bf16 v[30:33], a[84:87], v[70:73], v[30:33]
  v_mul_f32 v137, v137, v53
  v_cvt_pk_bf16_f32 v146, v134, v135
  v_mfma_f32_16x16x32_bf16 v[34:37], a[88:91], v[70:73], v[34:37]
  v_cvt_pk_bf16_f32 v147, v136, v137
  v_mul_f32 v140, v140, v64
  v_mfma_f32_16x16x32_bf16 v[38:41], a[92:95], v[70:73], v[38:41]
  s_waitcnt lgkmcnt(3)
  ds_read_b128 v[70:73], v3 offset:41984
  v_mul_f32 v141, v141, v65
  v_mfma_f32_16x16x32_bf16 v[30:33], a[96:99], v[74:77], v[30:33]
  ds_write_b64 v6, v[146:147] offset:0
  v_mfma_f32_16x16x32_bf16 v[34:37], a[100:103], v[74:77], v[34:37]
  v_exp_f32_e64 v138, -v138
  v_mfma_f32_16x16x32_bf16 v[38:41], a[104:107], v[74:77], v[38:41]
  v_exp_f32_e64 v139, -v139
  v_mfma_f32_16x16x32_bf16 v[30:33], a[108:111], v[78:81], v[30:33]
  v_exp_f32_e64 v140, -v140
  v_mfma_f32_16x16x32_bf16 v[34:37], a[112:115], v[78:81], v[34:37]
  v_exp_f32_e64 v141, -v141
  v_mfma_f32_16x16x32_bf16 v[38:41], a[116:119], v[78:81], v[38:41]
  s_waitcnt lgkmcnt(3)
  v_add_f32 v138, 1.0, v138
  v_add_f32 v139, 1.0, v139
  v_mfma_f32_16x16x32_bf16 v[30:33], a[120:123], v[54:57], v[30:33]
  v_add_f32 v140, 1.0, v140
  v_add_f32 v141, 1.0, v141
  v_rcp_f32 v138, v138
  v_rcp_f32 v139, v139
  v_rcp_f32 v140, v140
  v_rcp_f32 v141, v141
  v_mul_f32 v138, v138, v62
  v_mul_f32 v139, v139, v63
  v_mul_f32 v140, v140, v64
  v_mul_f32 v141, v141, v65
  v_cvt_pk_bf16_f32 v142, v138, v139
  v_cvt_pk_bf16_f32 v143, v140, v141
  ds_write_b64 v0, v[142:143] offset:6144
  v_mfma_f32_16x16x32_bf16 v[34:37], a[124:127], v[54:57], v[34:37]
  v_fma_f32 v134, v18, v18, s68
  v_fma_f32 v135, v19, v19, s68
  v_mfma_f32_16x16x32_bf16 v[38:41], a[128:131], v[54:57], v[38:41]
  v_fma_f32 v136, v20, v20, s68
  v_fma_f32 v137, v21, v21, s68
  v_mfma_f32_16x16x32_bf16 v[30:33], a[132:135], v[58:61], v[30:33]
  v_mul_f32 v134, v134, v18
  v_mul_f32 v135, v135, v19
  v_mfma_f32_16x16x32_bf16 v[34:37], a[136:139], v[58:61], v[34:37]
  s_waitcnt vmcnt(0) lgkmcnt(0)
  s_barrier
  v_mfma_f32_16x16x32_bf16 v[38:41], a[140:143], v[58:61], v[38:41]
  ds_read_b128 v[82:85], v4 offset:0
  v_mul_f32 v136, v136, v20
  v_mfma_f32_16x16x32_bf16 v[30:33], a[144:147], v[66:69], v[30:33]
  ds_read_b128 v[86:89], v4 offset:1024
  v_mul_f32 v137, v137, v21
  v_mfma_f32_16x16x32_bf16 v[34:37], a[148:151], v[66:69], v[34:37]
  ds_read_b128 v[90:93], v4 offset:2048
  v_fma_f32 v138, v22, v22, s68
  v_mfma_f32_16x16x32_bf16 v[38:41], a[152:155], v[66:69], v[38:41]
  ds_read_b128 v[94:97], v4 offset:3072
  v_fma_f32 v139, v23, v23, s68
  v_mfma_f32_16x16x32_bf16 v[30:33], a[156:159], v[70:73], v[30:33]
  ds_read_b128 v[98:101], v4 offset:4096
  v_fma_f32 v140, v24, v24, s68
  v_mfma_f32_16x16x32_bf16 v[34:37], a[160:163], v[70:73], v[34:37]
  ds_read_b128 v[102:105], v4 offset:5120
  v_fma_f32 v141, v25, v25, s68
  v_mfma_f32_16x16x32_bf16 v[38:41], a[164:167], v[70:73], v[38:41]
  s_waitcnt lgkmcnt(4)
  ds_read_b128 v[106:109], v4 offset:6144
  v_mul_f32 v138, v138, v22
  v_mfma_f32_16x16x32_bf16 v[110:113], a[168:171], v[82:85], 0
  v_exp_f32_e64 v134, -v134
  v_mfma_f32_16x16x32_bf16 v[114:117], a[172:175], v[82:85], 0
  v_exp_f32_e64 v135, -v135
  v_mfma_f32_16x16x32_bf16 v[110:113], a[196:199], v[86:89], v[110:113]
  v_exp_f32_e64 v136, -v136
  v_mfma_f32_16x16x32_bf16 v[114:117], a[200:203], v[86:89], v[114:117]
  s_waitcnt lgkmcnt(2)
  v_exp_f32_e64 v137, -v137
  v_mfma_f32_16x16x32_bf16 v[110:113], a[224:227], v[90:93], v[110:113]
  v_add_f32 v134, 1.0, v134
  v_add_f32 v135, 1.0, v135
  v_mfma_f32_16x16x32_bf16 v[114:117], a[228:231], v[90:93], v[114:117]
  v_add_f32 v136, 1.0, v136
  v_add_f32 v137, 1.0, v137
  v_mfma_f32_16x16x32_bf16 v[110:113], a[252:255], v[94:97], v[110:113]
  v_rcp_f32 v134, v134
  v_mfma_f32_16x16x32_bf16 v[114:117], v[148:151], v[94:97], v[114:117]
  v_rcp_f32 v135, v135
  v_mfma_f32_16x16x32_bf16 v[110:113], v[172:175], v[98:101], v[110:113]
  v_rcp_f32 v136, v136
  v_mfma_f32_16x16x32_bf16 v[114:117], v[176:179], v[98:101], v[114:117]
  s_waitcnt lgkmcnt(0)
  v_rcp_f32 v137, v137
  v_mfma_f32_16x16x32_bf16 v[110:113], v[200:203], v[102:105], v[110:113]
  v_mul_f32 v134, v134, v18
  v_mul_f32 v135, v135, v19
  v_mfma_f32_16x16x32_bf16 v[114:117], v[204:207], v[102:105], v[114:117]
  v_mul_f32 v136, v136, v20
  v_mul_f32 v137, v137, v21
  v_mfma_f32_16x16x32_bf16 v[110:113], v[228:231], v[106:109], v[110:113]
  v_cvt_pk_bf16_f32 v142, v134, v135
  v_cvt_pk_bf16_f32 v143, v136, v137
  v_mfma_f32_16x16x32_bf16 v[114:117], v[232:235], v[106:109], v[114:117]
  v_mul_f32 v139, v139, v23
  v_mul_f32 v140, v140, v24
  v_mfma_f32_16x16x32_bf16 v[118:121], a[176:179], v[82:85], 0
  v_mul_f32 v141, v141, v25
  v_fma_f32 v134, v26, v26, s68
  v_mfma_f32_16x16x32_bf16 v[122:125], a[180:183], v[82:85], 0
  v_exp_f32_e64 v138, -v138
  v_mfma_f32_16x16x32_bf16 v[118:121], a[204:207], v[86:89], v[118:121]
  v_cvt_pk_bf16_f32 v126, v110, v111
  v_cvt_pk_bf16_f32 v127, v112, v113
  v_mfma_f32_16x16x32_bf16 v[122:125], a[208:211], v[86:89], v[122:125]
  v_cvt_pk_bf16_f32 v128, v114, v115
  v_cvt_pk_bf16_f32 v129, v116, v117
  v_mfma_f32_16x16x32_bf16 v[118:121], a[232:235], v[90:93], v[118:121]
  buffer_store_dwordx4 v[126:129], v9, s[32:35], s74 offen offset:0 sc1
  v_exp_f32_e64 v139, -v139
  v_mfma_f32_16x16x32_bf16 v[122:125], a[236:239], v[90:93], v[122:125]
  v_exp_f32_e64 v140, -v140
  v_mfma_f32_16x16x32_bf16 v[118:121], v[152:155], v[94:97], v[118:121]
  v_exp_f32_e64 v141, -v141
  v_mfma_f32_16x16x32_bf16 v[122:125], v[156:159], v[94:97], v[122:125]
  v_add_f32 v138, 1.0, v138
  v_add_f32 v139, 1.0, v139
  v_mfma_f32_16x16x32_bf16 v[118:121], v[180:183], v[98:101], v[118:121]
  v_add_f32 v140, 1.0, v140
  v_add_f32 v141, 1.0, v141
  v_mfma_f32_16x16x32_bf16 v[122:125], v[184:187], v[98:101], v[122:125]
  v_rcp_f32 v138, v138
  v_mfma_f32_16x16x32_bf16 v[118:121], v[208:211], v[102:105], v[118:121]
  v_rcp_f32 v139, v139
  v_mfma_f32_16x16x32_bf16 v[122:125], v[212:215], v[102:105], v[122:125]
  v_rcp_f32 v140, v140
  v_mfma_f32_16x16x32_bf16 v[118:121], v[236:239], v[106:109], v[118:121]
  v_rcp_f32 v141, v141
  v_mfma_f32_16x16x32_bf16 v[122:125], v[240:243], v[106:109], v[122:125]
  v_mul_f32 v138, v138, v22
  v_mul_f32 v139, v139, v23
  v_mfma_f32_16x16x32_bf16 v[110:113], a[184:187], v[82:85], 0
  v_mul_f32 v140, v140, v24
  v_mul_f32 v141, v141, v25
  v_mfma_f32_16x16x32_bf16 v[114:117], a[188:191], v[82:85], 0
  v_cvt_pk_bf16_f32 v144, v138, v139
  v_cvt_pk_bf16_f32 v145, v140, v141
  v_mfma_f32_16x16x32_bf16 v[110:113], a[212:215], v[86:89], v[110:113]
  v_cvt_pk_bf16_f32 v130, v118, v119
  v_cvt_pk_bf16_f32 v131, v120, v121
  v_mfma_f32_16x16x32_bf16 v[114:117], a[216:219], v[86:89], v[114:117]
  v_cvt_pk_bf16_f32 v132, v122, v123
  v_cvt_pk_bf16_f32 v133, v124, v125
  v_mfma_f32_16x16x32_bf16 v[110:113], a[240:243], v[90:93], v[110:113]
  buffer_store_dwordx4 v[130:133], v9, s[32:35], s74 offen offset:128 sc1
  v_fma_f32 v135, v27, v27, s68
  v_fma_f32 v136, v28, v28, s68
  v_mfma_f32_16x16x32_bf16 v[114:117], a[244:247], v[90:93], v[114:117]
  ds_write_b128 v5, v[142:145] offset:7168
  v_mfma_f32_16x16x32_bf16 v[110:113], v[160:163], v[94:97], v[110:113]
  v_fma_f32 v137, v29, v29, s68
  v_mul_f32 v134, v134, v26
  v_mfma_f32_16x16x32_bf16 v[114:117], v[164:167], v[94:97], v[114:117]
  v_mul_f32 v135, v135, v27
  v_mul_f32 v136, v136, v28
  v_mfma_f32_16x16x32_bf16 v[110:113], v[188:191], v[98:101], v[110:113]
  v_mul_f32 v137, v137, v29
  v_fma_f32 v138, v30, v30, s68
  v_mfma_f32_16x16x32_bf16 v[114:117], v[192:195], v[98:101], v[114:117]
  v_exp_f32_e64 v134, -v134
  v_exp_f32_e64 v135, -v135
  v_exp_f32_e64 v136, -v136
  v_exp_f32_e64 v137, -v137
  v_add_f32 v134, 1.0, v134
  v_add_f32 v135, 1.0, v135
  v_add_f32 v136, 1.0, v136
  v_add_f32 v137, 1.0, v137
  v_rcp_f32 v134, v134
  v_rcp_f32 v135, v135
  v_rcp_f32 v136, v136
  v_rcp_f32 v137, v137
  v_mul_f32 v134, v134, v26
  v_mul_f32 v135, v135, v27
  v_mul_f32 v136, v136, v28
  v_mul_f32 v137, v137, v29
  v_cvt_pk_bf16_f32 v146, v134, v135
  v_cvt_pk_bf16_f32 v147, v136, v137
  ds_write_b64 v6, v[146:147] offset:7168
  v_mfma_f32_16x16x32_bf16 v[110:113], v[216:219], v[102:105], v[110:113]
  v_fma_f32 v139, v31, v31, s68
  v_fma_f32 v140, v32, v32, s68
  v_mfma_f32_16x16x32_bf16 v[114:117], v[220:223], v[102:105], v[114:117]
  v_fma_f32 v141, v33, v33, s68
  v_mul_f32 v138, v138, v30
  v_mfma_f32_16x16x32_bf16 v[110:113], v[244:247], v[106:109], v[110:113]
  v_mul_f32 v139, v139, v31
  v_mul_f32 v140, v140, v32
  v_mfma_f32_16x16x32_bf16 v[114:117], v[248:251], v[106:109], v[114:117]
  s_waitcnt lgkmcnt(0)
  s_barrier
  v_mfma_f32_16x16x32_bf16 v[118:121], a[192:195], v[82:85], 0
  ds_read_b128 v[82:85], v4 offset:7168
  v_mul_f32 v141, v141, v33
  v_mfma_f32_16x16x32_bf16 v[118:121], a[220:223], v[86:89], v[118:121]
  ds_read_b128 v[86:89], v4 offset:8192
  v_cvt_pk_bf16_f32 v126, v110, v111
  v_cvt_pk_bf16_f32 v127, v112, v113
  v_mfma_f32_16x16x32_bf16 v[118:121], a[248:251], v[90:93], v[118:121]
  ds_read_b128 v[90:93], v4 offset:9216
  v_cvt_pk_bf16_f32 v128, v114, v115
  v_cvt_pk_bf16_f32 v129, v116, v117
  v_mfma_f32_16x16x32_bf16 v[118:121], v[168:171], v[94:97], v[118:121]
  buffer_store_dwordx4 v[126:129], v9, s[32:35], s74 offen offset:256 sc1
  ds_read_b128 v[94:97], v4 offset:10240
  v_fma_f32 v134, v34, v34, s68
  v_mfma_f32_16x16x32_bf16 v[118:121], v[196:199], v[98:101], v[118:121]
  ds_read_b128 v[98:101], v4 offset:11264
  v_fma_f32 v135, v35, v35, s68
  v_mfma_f32_16x16x32_bf16 v[118:121], v[224:227], v[102:105], v[118:121]
  ds_read_b128 v[102:105], v4 offset:12288
  v_fma_f32 v136, v36, v36, s68
  v_mfma_f32_16x16x32_bf16 v[118:121], v[252:255], v[106:109], v[118:121]
  s_waitcnt lgkmcnt(4)
  ds_read_b128 v[106:109], v4 offset:13312
  v_fma_f32 v137, v37, v37, s68
  v_mfma_f32_16x16x32_bf16 v[110:113], a[168:171], v[82:85], 0
  v_exp_f32_e64 v138, -v138
  v_mfma_f32_16x16x32_bf16 v[114:117], a[172:175], v[82:85], 0
  v_exp_f32_e64 v139, -v139
  v_mfma_f32_16x16x32_bf16 v[110:113], a[196:199], v[86:89], v[110:113]
  v_cvt_pk_bf16_f32 v130, v118, v119
  v_cvt_pk_bf16_f32 v131, v120, v121
  v_mfma_f32_16x16x32_bf16 v[114:117], a[200:203], v[86:89], v[114:117]
  s_waitcnt lgkmcnt(2)
  v_exp_f32_e64 v140, -v140
  v_mfma_f32_16x16x32_bf16 v[110:113], a[224:227], v[90:93], v[110:113]
  v_permlane16_swap_b32 v130, v132
  v_mfma_f32_16x16x32_bf16 v[114:117], a[228:231], v[90:93], v[114:117]
  ds_read_b128 v[42:45], v7 offset:0
  v_mul_f32 v134, v134, v34
  v_mfma_f32_16x16x32_bf16 v[110:113], a[252:255], v[94:97], v[110:113]
  v_permlane16_swap_b32 v131, v133
  v_mfma_f32_16x16x32_bf16 v[114:117], v[148:151], v[94:97], v[114:117]
  buffer_store_dwordx4 v[130:133], v10, s[32:35], s74 offen offset:0 sc1
  v_exp_f32_e64 v141, -v141
  v_mfma_f32_16x16x32_bf16 v[110:113], v[172:175], v[98:101], v[110:113]
  ds_read_b128 v[46:49], v7 offset:2048
  v_add_f32 v138, 1.0, v138
  v_mfma_f32_16x16x32_bf16 v[114:117], v[176:179], v[98:101], v[114:117]
  s_waitcnt lgkmcnt(2)
  v_add_f32 v139, 1.0, v139
  v_add_f32 v140, 1.0, v140
  v_mfma_f32_16x16x32_bf16 v[110:113], v[200:203], v[102:105], v[110:113]
  v_add_f32 v141, 1.0, v141
  v_mul_f32 v135, v135, v35
  v_mfma_f32_16x16x32_bf16 v[114:117], v[204:207], v[102:105], v[114:117]
  ds_read_b128 v[50:53], v7 offset:4096
  v_mul_f32 v136, v136, v36
  v_mfma_f32_16x16x32_bf16 v[110:113], v[228:231], v[106:109], v[110:113]
  v_rcp_f32 v138, v138
  v_mfma_f32_16x16x32_bf16 v[114:117], v[232:235], v[106:109], v[114:117]
  v_rcp_f32 v139, v139
  v_mfma_f32_16x16x32_bf16 v[118:121], a[176:179], v[82:85], 0
  ds_read_b128 v[18:21], v7 offset:6144
  v_mul_f32 v137, v137, v37
  v_mfma_f32_16x16x32_bf16 v[122:125], a[180:183], v[82:85], 0
  v_rcp_f32 v140, v140
  v_mfma_f32_16x16x32_bf16 v[118:121], a[204:207], v[86:89], v[118:121]
  v_cvt_pk_bf16_f32 v126, v110, v111
  v_cvt_pk_bf16_f32 v127, v112, v113
  v_mfma_f32_16x16x32_bf16 v[122:125], a[208:211], v[86:89], v[122:125]
  ds_read_b128 v[22:25], v7 offset:8192
  v_cvt_pk_bf16_f32 v128, v114, v115
  v_cvt_pk_bf16_f32 v129, v116, v117
  v_mfma_f32_16x16x32_bf16 v[118:121], a[232:235], v[90:93], v[118:121]
  buffer_store_dwordx4 v[126:129], v9, s[32:35], s58 offen offset:0 sc1
  v_rcp_f32 v141, v141
  v_mfma_f32_16x16x32_bf16 v[122:125], a[236:239], v[90:93], v[122:125]
  v_mul_f32 v138, v138, v30
  v_mul_f32 v139, v139, v31
  v_mfma_f32_16x16x32_bf16 v[118:121], v[152:155], v[94:97], v[118:121]
  ds_read_b128 v[26:29], v7 offset:10240
  v_mul_f32 v140, v140, v32
  v_mfma_f32_16x16x32_bf16 v[122:125], v[156:159], v[94:97], v[122:125]
  v_mul_f32 v141, v141, v33
  v_cvt_pk_bf16_f32 v142, v138, v139
  v_mfma_f32_16x16x32_bf16 v[118:121], v[180:183], v[98:101], v[118:121]
  ds_read_b128 v[74:77], v17 offset:28672
  v_add_u32 v62, s66, v8
  v_mfma_f32_16x16x32_bf16 v[122:125], v[184:187], v[98:101], v[122:125]
  ds_read_b128 v[62:65], v62
  v_cvt_pk_bf16_f32 v143, v140, v141
  v_mfma_f32_16x16x32_bf16 v[118:121], v[208:211], v[102:105], v[118:121]
  v_exp_f32_e64 v134, -v134
  v_mfma_f32_16x16x32_bf16 v[122:125], v[212:215], v[102:105], v[122:125]
  ds_read_b128 v[78:81], v17 offset:29696
  v_fma_f32 v138, v38, v38, s68
  v_mfma_f32_16x16x32_bf16 v[118:121], v[236:239], v[106:109], v[118:121]
  v_exp_f32_e64 v135, -v135
  v_mfma_f32_16x16x32_bf16 v[122:125], v[240:243], v[106:109], v[122:125]
  v_exp_f32_e64 v136, -v136
  v_mfma_f32_16x16x32_bf16 v[110:113], a[184:187], v[82:85], 0
  ds_read_b128 v[54:57], v17 offset:30720
  v_fma_f32 v139, v39, v39, s68
  v_mfma_f32_16x16x32_bf16 v[114:117], a[188:191], v[82:85], 0
  v_exp_f32_e64 v137, -v137
  v_mfma_f32_16x16x32_bf16 v[110:113], a[212:215], v[86:89], v[110:113]
  v_cvt_pk_bf16_f32 v130, v118, v119
  v_cvt_pk_bf16_f32 v131, v120, v121
  v_mfma_f32_16x16x32_bf16 v[114:117], a[216:219], v[86:89], v[114:117]
  ds_read_b128 v[58:61], v17 offset:31744
  v_cvt_pk_bf16_f32 v132, v122, v123
  v_cvt_pk_bf16_f32 v133, v124, v125
  v_mfma_f32_16x16x32_bf16 v[110:113], a[240:243], v[90:93], v[110:113]
  buffer_store_dwordx4 v[130:133], v9, s[32:35], s58 offen offset:128 sc1
  v_add_f32 v134, 1.0, v134
  v_add_f32 v135, 1.0, v135
  v_mfma_f32_16x16x32_bf16 v[114:117], a[244:247], v[90:93], v[114:117]
  v_add_f32 v136, 1.0, v136
  v_add_f32 v137, 1.0, v137
  v_mfma_f32_16x16x32_bf16 v[110:113], v[160:163], v[94:97], v[110:113]
  ds_read_b128 v[66:69], v17 offset:32768
  v_fma_f32 v140, v40, v40, s68
  v_mfma_f32_16x16x32_bf16 v[114:117], v[164:167], v[94:97], v[114:117]
  v_rcp_f32 v134, v134
  v_mfma_f32_16x16x32_bf16 v[110:113], v[188:191], v[98:101], v[110:113]
  v_rcp_f32 v135, v135
  v_mfma_f32_16x16x32_bf16 v[114:117], v[192:195], v[98:101], v[114:117]
  ds_read_b128 v[70:73], v17 offset:33792
  v_fma_f32 v141, v41, v41, s68
  v_mfma_f32_16x16x32_bf16 v[110:113], v[216:219], v[102:105], v[110:113]
  v_rcp_f32 v136, v136
  v_mfma_f32_16x16x32_bf16 v[114:117], v[220:223], v[102:105], v[114:117]
  v_rcp_f32 v137, v137
  v_mfma_f32_16x16x32_bf16 v[110:113], v[244:247], v[106:109], v[110:113]
  v_mul_f32 v134, v134, v34
  v_mul_f32 v135, v135, v35
  v_mfma_f32_16x16x32_bf16 v[114:117], v[248:251], v[106:109], v[114:117]
  v_mul_f32 v136, v136, v36
  v_mul_f32 v137, v137, v37
  v_mfma_f32_16x16x32_bf16 v[118:121], a[192:195], v[82:85], 0
  ds_read_b128 v[82:85], v7 offset:12288
  v_cvt_pk_bf16_f32 v144, v134, v135
  v_mfma_f32_16x16x32_bf16 v[118:121], a[220:223], v[86:89], v[118:121]
  ds_read_b128 v[86:89], v7 offset:14336
  v_cvt_pk_bf16_f32 v126, v110, v111
  v_cvt_pk_bf16_f32 v127, v112, v113
  v_mfma_f32_16x16x32_bf16 v[118:121], a[248:251], v[90:93], v[118:121]
  ds_read_b128 v[90:93], v7 offset:16384
  v_cvt_pk_bf16_f32 v128, v114, v115
  v_cvt_pk_bf16_f32 v129, v116, v117
  v_mfma_f32_16x16x32_bf16 v[118:121], v[168:171], v[94:97], v[118:121]
  buffer_store_dwordx4 v[126:129], v9, s[32:35], s58 offen offset:256 sc1
  ds_read_b128 v[94:97], v7 offset:18432
  v_cvt_pk_bf16_f32 v145, v136, v137
  v_mfma_f32_16x16x32_bf16 v[118:121], v[196:199], v[98:101], v[118:121]
  ds_read_b128 v[98:101], v7 offset:20480
  v_mul_f32 v138, v138, v38
  v_mfma_f32_16x16x32_bf16 v[118:121], v[224:227], v[102:105], v[118:121]
  ds_read_b128 v[102:105], v7 offset:22528
  v_mul_f32 v139, v139, v39
  v_mfma_f32_16x16x32_bf16 v[118:121], v[252:255], v[106:109], v[118:121]
  s_waitcnt lgkmcnt(10)
  ds_read_b128 v[106:109], v7 offset:24576
  v_mul_f32 v140, v140, v40
  v_mfma_f32_16x16x32_bf16 v[62:65], v[42:45], v[74:77], v[62:65]
  ds_read_b128 v[74:77], v17 offset:34816
  v_mul_f32 v141, v141, v41
  v_mfma_f32_16x16x32_bf16 v[62:65], v[46:49], v[78:81], v[62:65]
  s_waitcnt lgkmcnt(10)
  ds_read_b128 v[78:81], v17 offset:35840
  s_nop 0
  v_mfma_f32_16x16x32_bf16 v[62:65], v[50:53], v[54:57], v[62:65]
  ds_read_b128 v[54:57], v17 offset:36864
  v_cvt_pk_bf16_f32 v130, v118, v119
  v_cvt_pk_bf16_f32 v131, v120, v121
  v_mfma_f32_16x16x32_bf16 v[62:65], v[18:21], v[58:61], v[62:65]
  s_waitcnt lgkmcnt(10)
  ds_read_b128 v[58:61], v17 offset:37888
  ds_read_b128 v[18:21], v7 offset:26624
  v_mfma_f32_16x16x32_bf16 v[62:65], v[22:25], v[66:69], v[62:65]
  ds_read_b128 v[66:69], v17 offset:38912
  v_permlane16_swap_b32 v130, v132
  v_mfma_f32_16x16x32_bf16 v[62:65], v[26:29], v[70:73], v[62:65]
  s_waitcnt lgkmcnt(4)
  ds_read_b128 v[70:73], v17 offset:39936
  ds_read_b128 v[42:45], v8 offset:0
  v_mfma_f32_16x16x32_bf16 v[62:65], v[82:85], v[74:77], v[62:65]
  ds_read_b128 v[74:77], v17 offset:40960
  v_permlane16_swap_b32 v131, v133
  v_mfma_f32_16x16x32_bf16 v[62:65], v[86:89], v[78:81], v[62:65]
  s_waitcnt lgkmcnt(5)
  buffer_store_dwordx4 v[130:133], v10, s[32:35], s58 offen offset:0 sc1
  ds_read_b128 v[78:81], v17 offset:41984
  ds_read_b128 v[46:49], v8 offset:64
  v_mfma_f32_16x16x32_bf16 v[62:65], v[90:93], v[54:57], v[62:65]
  ds_read_b128 v[54:57], v3 offset:43008
  v_mfma_f32_16x16x32_bf16 v[62:65], v[94:97], v[58:61], v[62:65]
  s_waitcnt lgkmcnt(5)
  ds_read_b128 v[58:61], v3 offset:44032
  ds_read_b128 v[50:53], v8 offset:128
  v_mfma_f32_16x16x32_bf16 v[62:65], v[98:101], v[66:69], v[62:65]
  ds_read_b128 v[66:69], v3 offset:45056
  v_mfma_f32_16x16x32_bf16 v[62:65], v[102:105], v[70:73], v[62:65]
  s_waitcnt lgkmcnt(5)
  ds_read_b128 v[70:73], v3 offset:46080
  v_mfma_f32_16x16x32_bf16 v[62:65], v[106:109], v[74:77], v[62:65]
  ds_read_b128 v[74:77], v3 offset:47104
  v_mfma_f32_16x16x32_bf16 v[62:65], v[18:21], v[78:81], v[62:65]
  s_waitcnt lgkmcnt(4)
  ds_read_b128 v[78:81], v3 offset:48128
L_hop3:
  s_cbranch_execz L_hopret
  v_mfma_f32_16x16x32_bf16 v[42:45], a[0:3], v[54:57], v[42:45]
  ds_write_b128 v5, v[142:145] offset:14336
  v_mfma_f32_16x16x32_bf16 v[46:49], a[4:7], v[54:57], v[46:49]
  s_waitcnt lgkmcnt(5)
  v_exp_f32_e64 v138, -v138
  v_mfma_f32_16x16x32_bf16 v[50:53], a[8:11], v[54:57], v[50:53]
  ds_read_b128 v[54:57], v3 offset:49152
  v_mfma_f32_16x16x32_bf16 v[42:45], a[12:15], v[58:61], v[42:45]
  v_exp_f32_e64 v139, -v139
  v_mfma_f32_16x16x32_bf16 v[46:49], a[16:19], v[58:61], v[46:49]
  v_exp_f32_e64 v140, -v140
  v_mfma_f32_16x16x32_bf16 v[50:53], a[20:23], v[58:61], v[50:53]
  s_waitcnt lgkmcnt(4)
  ds_read_b128 v[58:61], v3 offset:50176
  v_fma_f32 v134, v62, v62, s68
  v_mfma_f32_16x16x32_bf16 v[42:45], a[24:27], v[66:69], v[42:45]
  v_exp_f32_e64 v141, -v141
  v_mfma_f32_16x16x32_bf16 v[46:49], a[28:31], v[66:69], v[46:49]
  v_add_f32 v138, 1.0, v138
  v_add_f32 v139, 1.0, v139
  v_mfma_f32_16x16x32_bf16 v[50:53], a[32:35], v[66:69], v[50:53]
  ds_read_b128 v[66:69], v3 offset:51200
  v_add_f32 v140, 1.0, v140
  v_mfma_f32_16x16x32_bf16 v[42:45], a[36:39], v[70:73], v[42:45]
  v_add_f32 v141, 1.0, v141
  v_fma_f32 v135, v63, v63, s68
  v_mfma_f32_16x16x32_bf16 v[46:49], a[40:43], v[70:73], v[46:49]
  v_rcp_f32 v138, v138
  v_mfma_f32_16x16x32_bf16 v[50:53], a[44:47], v[70:73], v[50:53]
  s_waitcnt lgkmcnt(4)
  ds_read_b128 v[70:73], v3 offset:52224
  v_fma_f32 v136, v64, v64, s68
  v_mfma_f32_16x16x32_bf16 v[42:45], a[48:51], v[74:77], v[42:45]
  v_rcp_f32 v139, v139
  v_mfma_f32_16x16x32_bf16 v[46:49], a[52:55], v[74:77], v[46:49]
  v_rcp_f32 v140, v140
  v_mfma_f32_16x16x32_bf16 v[50:53], a[56:59], v[74:77], v[50:53]
  ds_read_b128 v[74:77], v3 offset:53248
  v_fma_f32 v137, v65, v65, s68
  v_mfma_f32_16x16x32_bf16 v[42:45], a[60:63], v[78:81], v[42:45]
  v_rcp_f32 v141, v141
  v_mfma_f32_16x16x32_bf16 v[46:49], a[64:67], v[78:81], v[46:49]
  v_mul_f32 v138, v138, v38
  v_mul_f32 v139, v139, v39
  v_mfma_f32_16x16x32_bf16 v[50:53], a[68:71], v[78:81], v[50:53]
  s_waitcnt lgkmcnt(3)
  ds_read_b128 v[78:81], v3 offset:54272
  v_mul_f32 v140, v140, v40
  v_mfma_f32_16x16x32_bf16 v[42:45], a[72:75], v[54:57], v[42:45]
  v_mul_f32 v141, v141, v41
  v_cvt_pk_bf16_f32 v146, v138, v139
  v_mfma_f32_16x16x32_bf16 v[46:49], a[76:79], v[54:57], v[46:49]
  v_cvt_pk_bf16_f32 v147, v140, v141
  v_mul_f32 v134, v134, v62
  v_mfma_f32_16x16x32_bf16 v[50:53], a[80:83], v[54:57], v[50:53]
  ds_read_b128 v[54:57], v3 offset:55296
  v_mul_f32 v135, v135, v63
  v_mfma_f32_16x16x32_bf16 v[42:45], a[84:87], v[58:61], v[42:45]
  ds_write_b64 v6, v[146:147] offset:14336
  v_mfma_f32_16x16x32_bf16 v[46:49], a[88:91], v[58:61], v[46:49]
  v_mul_f32 v136, v136, v64
  v_mul_f32 v137, v137, v65
  v_mfma_f32_16x16x32_bf16 v[50:53], a[92:95], v[58:61], v[50:53]
  s_waitcnt lgkmcnt(4)
  ds_read_b128 v[58:61], v3 offset:56320
  v_mfma_f32_16x16x32_bf16 v[42:45], a[96:99], v[66:69], v[42:45]
  s_waitcnt vmcnt(0)
  v_exp_f32_e64 v134, -v134
  v_mfma_f32_16x16x32_bf16 v[46:49], a[100:103], v[66:69], v[46:49]
  s_cmp_lg_u32 s82, 0
  s_cbranch_scc1 L_far14
  buffer_store_dword v12, v2, s[32:35], s64 offen offset:768
L_near14:
  v_mfma_f32_16x16x32_bf16 v[50:53], a[104:107], v[66:69], v[50:53]
  v_exp_f32_e64 v135, -v135
  v_mfma_f32_16x16x32_bf16 v[42:45], a[108:111], v[70:73], v[42:45]
  v_exp_f32_e64 v136, -v136
  v_mfma_f32_16x16x32_bf16 v[46:49], a[112:115], v[70:73], v[46:49]
  v_exp_f32_e64 v137, -v137
  v_mfma_f32_16x16x32_bf16 v[50:53], a[116:119], v[70:73], v[50:53]
  s_waitcnt lgkmcnt(3)
  v_add_f32 v134, 1.0, v134
  v_add_f32 v135, 1.0, v135
  v_mfma_f32_16x16x32_bf16 v[42:45], a[120:123], v[74:77], v[42:45]
  v_add_f32 v136, 1.0, v136
  v_add_f32 v137, 1.0, v137
  v_rcp_f32 v134, v134
  v_rcp_f32 v135, v135
  v_rcp_f32 v136, v136
  v_rcp_f32 v137, v137
  v_mul_f32 v134, v134, v62
  v_mul_f32 v135, v135, v63
  v_mul_f32 v136, v136, v64
  v_mul_f32 v137, v137, v65
  v_cvt_pk_bf16_f32 v142, v134, v135
  v_cvt_pk_bf16_f32 v143, v136, v137
  ds_write_b64 v0, v[142:143] offset:20480
  v_mfma_f32_16x16x32_bf16 v[46:49], a[124:127], v[74:77], v[46:49]
  v_mfma_f32_16x16x32_bf16 v[50:53], a[128:131], v[74:77], v[50:53]
  v_mfma_f32_16x16x32_bf16 v[42:45], a[132:135], v[78:81], v[42:45]
  v_mfma_f32_16x16x32_bf16 v[46:49], a[136:139], v[78:81], v[46:49]
  s_waitcnt lgkmcnt(0)
  s_barrier
  v_mfma_f32_16x16x32_bf16 v[50:53], a[140:143], v[78:81], v[50:53]
  ds_read_b128 v[82:85], v4 offset:14336
  v_mfma_f32_16x16x32_bf16 v[42:45], a[144:147], v[54:57], v[42:45]
  ds_read_b128 v[86:89], v4 offset:15360
  v_mfma_f32_16x16x32_bf16 v[46:49], a[148:151], v[54:57], v[46:49]
  ds_read_b128 v[90:93], v4 offset:16384
  v_mfma_f32_16x16x32_bf16 v[50:53], a[152:155], v[54:57], v[50:53]
  ds_read_b128 v[94:97], v4 offset:17408
  v_mfma_f32_16x16x32_bf16 v[42:45], a[156:159], v[58:61], v[42:45]
  ds_read_b128 v[98:101], v4 offset:18432
  v_mfma_f32_16x16x32_bf16 v[46:49], a[160:163], v[58:61], v[46:49]
  ds_read_b128 v[102:105], v4 offset:19456
  v_mfma_f32_16x16x32_bf16 v[50:53], a[164:167], v[58:61], v[50:53]
  s_waitcnt lgkmcnt(4)
  ds_read_b128 v[106:109], v4 offset:20480
  v_mfma_f32_16x16x32_bf16 v[110:113], a[168:171], v[82:85], 0
  buffer_load_dword v18, v1, s[32:35], s76 offen offset:768 sc1
  v_mfma_f32_16x16x32_bf16 v[114:117], a[172:175], v[82:85], 0
  s_add_u32 m0, s67, 106496
  v_add_u32 v59, 4294860928, v3
  v_mfma_f32_16x16x32_bf16 v[110:113], a[196:199], v[86:89], v[110:113]
  s_add_u32 s6, s74, 4096
  v_lshlrev_b32 v59, 20, v59
  v_mfma_f32_16x16x32_bf16 v[114:117], a[200:203], v[86:89], v[114:117]
  s_waitcnt lgkmcnt(2)
  v_and_b32 v59, 1073741824, v59
  v_fma_f32 v138, v42, v42, s68
  v_mfma_f32_16x16x32_bf16 v[110:113], a[224:227], v[90:93], v[110:113]
  v_lshrrev_b32 v58, 2, v3
  v_fma_f32 v139, v43, v43, s68
  v_mfma_f32_16x16x32_bf16 v[114:117], a[228:231], v[90:93], v[114:117]
  v_and_or_b32 v59, v58, 64, v59
  v_fma_f32 v140, v44, v44, s68
  v_mfma_f32_16x16x32_bf16 v[110:113], a[252:255], v[94:97], v[110:113]
  v_xad_u32 v58, v3, v59, s63
  v_fma_f32 v141, v45, v45, s68
  v_mfma_f32_16x16x32_bf16 v[114:117], v[148:151], v[94:97], v[114:117]
  v_mul_f32 v138, v138, v42
  v_mul_f32 v139, v139, v43
  v_mfma_f32_16x16x32_bf16 v[110:113], v[172:175], v[98:101], v[110:113]
  v_mul_f32 v140, v140, v44
  v_mul_f32 v141, v141, v45
  v_mfma_f32_16x16x32_bf16 v[114:117], v[176:179], v[98:101], v[114:117]
  s_waitcnt lgkmcnt(0)
  v_exp_f32_e64 v138, -v138
  v_mfma_f32_16x16x32_bf16 v[110:113], v[200:203], v[102:105], v[110:113]
  v_exp_f32_e64 v139, -v139
  v_mfma_f32_16x16x32_bf16 v[114:117], v[204:207], v[102:105], v[114:117]
  s_waitcnt vmcnt(0)
  v_cmp_ne_u32 vcc, s4, v18
  v_fma_f32 v134, v46, v46, s68
  v_mfma_f32_16x16x32_bf16 v[110:113], v[228:231], v[106:109], v[110:113]
  s_cbranch_vccnz L_spin15
L_done15:
  v_exp_f32_e64 v140, -v140
  v_mfma_f32_16x16x32_bf16 v[114:117], v[232:235], v[106:109], v[114:117]
  buffer_load_dwordx4 v58, s[32:35], s74 offen offset:0 sc1 lds
  v_exp_f32_e64 v141, -v141
  v_mfma_f32_16x16x32_bf16 v[118:121], a[176:179], v[82:85], 0
  v_add_f32 v138, 1.0, v138
  v_add_f32 v139, 1.0, v139
  v_mfma_f32_16x16x32_bf16 v[122:125], a[180:183], v[82:85], 0
  buffer_load_dwordx4 v58, s[32:35], s74 offen offset:1024 sc1 lds
  v_add_f32 v140, 1.0, v140
  v_add_f32 v141, 1.0, v141
  v_mfma_f32_16x16x32_bf16 v[118:121], a[204:207], v[86:89], v[118:121]
  v_cvt_pk_bf16_f32 v126, v110, v111
  v_cvt_pk_bf16_f32 v127, v112, v113
  v_mfma_f32_16x16x32_bf16 v[122:125], a[208:211], v[86:89], v[122:125]
  buffer_load_dwordx4 v58, s[32:35], s74 offen offset:2048 sc1 lds
  v_cvt_pk_bf16_f32 v128, v114, v115
  v_cvt_pk_bf16_f32 v129, v116, v117
  v_mfma_f32_16x16x32_bf16 v[118:121], a[232:235], v[90:93], v[118:121]
  buffer_store_dwordx4 v[126:129], v9, s[32:35], s59 offen offset:0 nt
  v_rcp_f32 v138, v138
  v_mfma_f32_16x16x32_bf16 v[122:125], a[236:239], v[90:93], v[122:125]
  buffer_load_dwordx4 v58, s[32:35], s74 offen offset:3072 sc1 lds
  v_rcp_f32 v139, v139
  v_mfma_f32_16x16x32_bf16 v[118:121], v[152:155], v[94:97], v[118:121]
  s_add_u32 m0, m0, 4096
  v_rcp_f32 v140, v140
  v_mfma_f32_16x16x32_bf16 v[122:125], v[156:159], v[94:97], v[122:125]
  buffer_load_dwordx4 v58, s[32:35], s6 offen offset:0 sc1 lds
  v_rcp_f32 v141, v141
  v_mfma_f32_16x16x32_bf16 v[118:121], v[180:183], v[98:101], v[118:121]
  v_mul_f32 v138, v138, v42
  v_mul_f32 v139, v139, v43
  v_mfma_f32_16x16x32_bf16 v[122:125], v[184:187], v[98:101], v[122:125]
  buffer_load_dwordx4 v58, s[32:35], s6 offen offset:1024 sc1 lds
  v_mul_f32 v140, v140, v44
  v_mul_f32 v141, v141, v45
  v_mfma_f32_16x16x32_bf16 v[118:121], v[208:211], v[102:105], v[118:121]
  v_cvt_pk_bf16_f32 v142, v138, v139
  v_cvt_pk_bf16_f32 v143, v140, v141
  v_mfma_f32_16x16x32_bf16 v[122:125], v[212:215], v[102:105], v[122:125]
  buffer_load_dwordx4 v58, s[32:35], s6 offen offset:2048 sc1 lds
  v_fma_f32 v135, v47, v47, s68
  v_fma_f32 v136, v48, v48, s68
  v_mfma_f32_16x16x32_bf16 v[118:121], v[236:239], v[106:109], v[118:121]
  v_fma_f32 v137, v49, v49, s68
  v_mul_f32 v134, v134, v46
  v_mfma_f32_16x16x32_bf16 v[122:125], v[240:243], v[106:109], v[122:125]
  buffer_load_dwordx4 v58, s[32:35], s6 offen offset:3072 sc1 lds
  v_mul_f32 v135, v135, v47
  v_mul_f32 v136, v136, v48
  v_mfma_f32_16x16x32_bf16 v[110:113], a[184:187], v[82:85], 0
  v_mul_f32 v137, v137, v49
  v_fma_f32 v138, v50, v50, s68
  v_mfma_f32_16x16x32_bf16 v[114:117], a[188:191], v[82:85], 0
  ds_read_b128 v[18:21], v15 offset:0
  v_fma_f32 v139, v51, v51, s68
  v_mfma_f32_16x16x32_bf16 v[110:113], a[212:215], v[86:89], v[110:113]
  v_cvt_pk_bf16_f32 v130, v118, v119
  v_cvt_pk_bf16_f32 v131, v120, v121
  v_mfma_f32_16x16x32_bf16 v[114:117], a[216:219], v[86:89], v[114:117]
  ds_read_b128 v[22:25], v15 offset:4096
  v_cvt_pk_bf16_f32 v132, v122, v123
  v_cvt_pk_bf16_f32 v133, v124, v125
  v_mfma_f32_16x16x32_bf16 v[110:113], a[240:243], v[90:93], v[110:113]
  buffer_store_dwordx4 v[130:133], v9, s[32:35], s59 offen offset:128 nt
  v_exp_f32_e64 v134, -v134
  v_mfma_f32_16x16x32_bf16 v[114:117], a[244:247], v[90:93], v[114:117]
  ds_read_b128 v[62:65], v15 offset:40960
  v_fma_f32 v140, v52, v52, s68
  v_mfma_f32_16x16x32_bf16 v[110:113], v[160:163], v[94:97], v[110:113]
  v_exp_f32_e64 v135, -v135
  v_mfma_f32_16x16x32_bf16 v[114:117], v[164:167], v[94:97], v[114:117]
  ds_read_b128 v[26:29], v15 offset:32768
  v_fma_f32 v141, v53, v53, s68
  v_mfma_f32_16x16x32_bf16 v[110:113], v[188:191], v[98:101], v[110:113]
  v_exp_f32_e64 v136, -v136
  v_mfma_f32_16x16x32_bf16 v[114:117], v[192:195], v[98:101], v[114:117]
  ds_read_b128 v[30:33], v15 offset:36864
  v_mul_f32 v138, v138, v50
  v_exp_f32_e64 v137, -v137
  v_add_f32 v134, 1.0, v134
  v_add_f32 v135, 1.0, v135
  v_add_f32 v136, 1.0, v136
  v_add_f32 v137, 1.0, v137
  v_rcp_f32 v134, v134
  v_rcp_f32 v135, v135
  v_rcp_f32 v136, v136
  v_rcp_f32 v137, v137
  v_mul_f32 v134, v134, v46
  v_mul_f32 v135, v135, v47
  v_mul_f32 v136, v136, v48
  v_mul_f32 v137, v137, v49
  v_cvt_pk_bf16_f32 v144, v134, v135
  v_cvt_pk_bf16_f32 v145, v136, v137
  ds_write_b128 v5, v[142:145] offset:21504
  v_mul_f32 v139, v139, v51
  v_mul_f32 v140, v140, v52
  v_mul_f32 v141, v141, v53
  v_exp_f32_e64 v138, -v138
  v_exp_f32_e64 v139, -v139
  v_exp_f32_e64 v140, -v140
  v_exp_f32_e64 v141, -v141
  v_add_f32 v138, 1.0, v138
  v_add_f32 v139, 1.0, v139
  v_add_f32 v140, 1.0, v140
  v_add_f32 v141, 1.0, v141
  v_rcp_f32 v138, v138
  v_rcp_f32 v139, v139
  v_rcp_f32 v140, v140
  v_rcp_f32 v141, v141
  v_mul_f32 v138, v138, v50
  v_mul_f32 v139, v139, v51
  v_mul_f32 v140, v140, v52
  v_mul_f32 v141, v141, v53
  v_cvt_pk_bf16_f32 v146, v138, v139
  v_cvt_pk_bf16_f32 v147, v140, v141
  ds_write_b64 v6, v[146:147] offset:21504
  v_mfma_f32_16x16x32_bf16 v[110:113], v[216:219], v[102:105], v[110:113]
  v_mfma_f32_16x16x32_bf16 v[114:117], v[220:223], v[102:105], v[114:117]
  ds_read_b128 v[34:37], v15 offset:8192
  v_mfma_f32_16x16x32_bf16 v[110:113], v[244:247], v[106:109], v[110:113]
  v_mfma_f32_16x16x32_bf16 v[114:117], v[248:251], v[106:109], v[114:117]
  s_waitcnt lgkmcnt(1)
  s_barrier
  ds_read_b128 v[38:41], v15 offset:12288
  v_mfma_f32_16x16x32_bf16 v[118:121], a[192:195], v[82:85], 0
  s_mov_b32 s83, 0x40088e99
  ds_read_b128 v[82:85], v4 offset:21504
  s_nop 0
  v_mfma_f32_16x16x32_bf16 v[118:121], a[220:223], v[86:89], v[118:121]
  ds_read_b128 v[86:89], v4 offset:22528
  v_cvt_pk_bf16_f32 v126, v110, v111
  v_cvt_pk_bf16_f32 v127, v112, v113
  v_mfma_f32_16x16x32_bf16 v[118:121], a[248:251], v[90:93], v[118:121]
  ds_read_b128 v[90:93], v4 offset:23552
  v_cvt_pk_bf16_f32 v128, v114, v115
  v_cvt_pk_bf16_f32 v129, v116, v117
  v_mfma_f32_16x16x32_bf16 v[118:121], v[168:171], v[94:97], v[118:121]
  buffer_store_dwordx4 v[126:129], v9, s[32:35], s59 offen offset:256 nt
  ds_read_b128 v[94:97], v4 offset:24576
  v_mfma_f32_16x16x32_bf16 v[118:121], v[196:199], v[98:101], v[118:121]
  ds_read_b128 v[98:101], v4 offset:25600
  v_mfma_f32_16x16x32_bf16 v[118:121], v[224:227], v[102:105], v[118:121]
  ds_read_b128 v[102:105], v4 offset:26624
  v_mfma_f32_16x16x32_bf16 v[118:121], v[252:255], v[106:109], v[118:121]
  s_waitcnt lgkmcnt(4)
  ds_read_b128 v[106:109], v4 offset:27648
  s_nop 0
  v_mfma_f32_16x16x32_bf16 v[110:113], a[168:171], v[82:85], 0
  s_nop 2
  v_mfma_f32_16x16x32_bf16 v[114:117], a[172:175], v[82:85], 0
  s_nop 2
  v_mfma_f32_16x16x32_bf16 v[110:113], a[196:199], v[86:89], v[110:113]
  v_cvt_pk_bf16_f32 v130, v118, v119
  v_cvt_pk_bf16_f32 v131, v120, v121
  v_mfma_f32_16x16x32_bf16 v[114:117], a[200:203], v[86:89], v[114:117]
  s_waitcnt lgkmcnt(2)
  v_mfma_f32_16x16x32_bf16 v[110:113], a[224:227], v[90:93], v[110:113]
  v_permlane16_swap_b32 v130, v132
  v_mfma_f32_16x16x32_bf16 v[114:117], a[228:231], v[90:93], v[114:117]
  v_mfma_f32_16x16x32_bf16 v[110:113], a[252:255], v[94:97], v[110:113]
  v_permlane16_swap_b32 v131, v133
  v_mfma_f32_16x16x32_bf16 v[114:117], v[148:151], v[94:97], v[114:117]
  buffer_store_dwordx4 v[130:133], v10, s[32:35], s59 offen offset:0 nt
  v_mfma_f32_16x16x32_bf16 v[110:113], v[172:175], v[98:101], v[110:113]
  v_mfma_f32_16x16x32_bf16 v[114:117], v[176:179], v[98:101], v[114:117]
  s_waitcnt lgkmcnt(0)
  v_mfma_f32_16x16x32_bf16 v[110:113], v[200:203], v[102:105], v[110:113]
  v_mfma_f32_16x16x32_bf16 v[114:117], v[204:207], v[102:105], v[114:117]
  v_mfma_f32_16x16x32_bf16 v[110:113], v[228:231], v[106:109], v[110:113]
  v_mfma_f32_16x16x32_bf16 v[114:117], v[232:235], v[106:109], v[114:117]
  s_nop 2
  v_mfma_f32_16x16x32_bf16 v[118:121], a[176:179], v[82:85], 0
  s_nop 2
  v_mfma_f32_16x16x32_bf16 v[122:125], a[180:183], v[82:85], 0
  s_nop 2
  v_mfma_f32_16x16x32_bf16 v[118:121], a[204:207], v[86:89], v[118:121]
  v_cvt_pk_bf16_f32 v126, v110, v111
  v_cvt_pk_bf16_f32 v127, v112, v113
  v_mfma_f32_16x16x32_bf16 v[122:125], a[208:211], v[86:89], v[122:125]
  v_cvt_pk_bf16_f32 v128, v114, v115
  v_cvt_pk_bf16_f32 v129, v116, v117
  v_mfma_f32_16x16x32_bf16 v[118:121], a[232:235], v[90:93], v[118:121]
  buffer_store_dwordx4 v[126:129], v9, s[32:35], s60 offen offset:0 nt
  v_mfma_f32_16x16x32_bf16 v[122:125], a[236:239], v[90:93], v[122:125]
  v_mfma_f32_16x16x32_bf16 v[118:121], v[152:155], v[94:97], v[118:121]
  v_mfma_f32_16x16x32_bf16 v[122:125], v[156:159], v[94:97], v[122:125]
  v_bfe_i32 v61, v11, 30, 1
  v_mfma_f32_16x16x32_bf16 v[118:121], v[180:183], v[98:101], v[118:121]
  v_and_b32 v61, 0x380, v61
  v_mfma_f32_16x16x32_bf16 v[122:125], v[184:187], v[98:101], v[122:125]
  v_and_b32 v59, 0x7fff, v11
  v_mfma_f32_16x16x32_bf16 v[118:121], v[208:211], v[102:105], v[118:121]
  v_or_b32 v59, v59, v61
  v_mfma_f32_16x16x32_bf16 v[122:125], v[212:215], v[102:105], v[122:125]
  v_lshrrev_b32 v61, 2, v59
  v_mfma_f32_16x16x32_bf16 v[118:121], v[236:239], v[106:109], v[118:121]
  v_and_b32 v61, 64, v61
  v_mfma_f32_16x16x32_bf16 v[122:125], v[240:243], v[106:109], v[122:125]
  v_xor_b32 v59, v59, v61
  s_nop 0
  v_mfma_f32_16x16x32_bf16 v[110:113], a[184:187], v[82:85], 0
  v_add_u32 v59, 106496, v59
  s_nop 0
  v_mfma_f32_16x16x32_bf16 v[114:117], a[188:191], v[82:85], 0
  s_nop 2
  v_mfma_f32_16x16x32_bf16 v[110:113], a[212:215], v[86:89], v[110:113]
  v_cvt_pk_bf16_f32 v130, v118, v119
  v_cvt_pk_bf16_f32 v131, v120, v121
  v_mfma_f32_16x16x32_bf16 v[114:117], a[216:219], v[86:89], v[114:117]
  v_cvt_pk_bf16_f32 v132, v122, v123
  v_cvt_pk_bf16_f32 v133, v124, v125
  v_mfma_f32_16x16x32_bf16 v[110:113], a[240:243], v[90:93], v[110:113]
  buffer_store_dwordx4 v[130:133], v9, s[32:35], s60 offen offset:128 nt
  v_mfma_f32_16x16x32_bf16 v[114:117], a[244:247], v[90:93], v[114:117]
  v_mfma_f32_16x16x32_bf16 v[110:113], v[160:163], v[94:97], v[110:113]
  v_mfma_f32_16x16x32_bf16 v[114:117], v[164:167], v[94:97], v[114:117]
  v_mfma_f32_16x16x32_bf16 v[110:113], v[188:191], v[98:101], v[110:113]
  v_mfma_f32_16x16x32_bf16 v[114:117], v[192:195], v[98:101], v[114:117]
  v_mfma_f32_16x16x32_bf16 v[110:113], v[216:219], v[102:105], v[110:113]
  v_mfma_f32_16x16x32_bf16 v[114:117], v[220:223], v[102:105], v[114:117]
  v_mfma_f32_16x16x32_bf16 v[110:113], v[244:247], v[106:109], v[110:113]
  v_mfma_f32_16x16x32_bf16 v[114:117], v[248:251], v[106:109], v[114:117]
  s_nop 2
  v_mfma_f32_16x16x32_bf16 v[118:121], a[192:195], v[82:85], 0
  s_nop 2
  v_mfma_f32_16x16x32_bf16 v[118:121], a[220:223], v[86:89], v[118:121]
  v_cvt_pk_bf16_f32 v126, v110, v111
  v_cvt_pk_bf16_f32 v127, v112, v113
  v_mfma_f32_16x16x32_bf16 v[118:121], a[248:251], v[90:93], v[118:121]
  v_cvt_pk_bf16_f32 v128, v114, v115
  v_cvt_pk_bf16_f32 v129, v116, v117
  v_mfma_f32_16x16x32_bf16 v[118:121], v[168:171], v[94:97], v[118:121]
  buffer_store_dwordx4 v[126:129], v9, s[32:35], s60 offen offset:256 nt
  v_mfma_f32_16x16x32_bf16 v[118:121], v[196:199], v[98:101], v[118:121]
  v_mfma_f32_16x16x32_bf16 v[118:121], v[224:227], v[102:105], v[118:121]
  v_mfma_f32_16x16x32_bf16 v[118:121], v[252:255], v[106:109], v[118:121]
  s_nop 2
  s_nop 4
  v_cvt_pk_bf16_f32 v130, v118, v119
  v_cvt_pk_bf16_f32 v131, v120, v121
  s_nop 0
  v_permlane16_swap_b32 v130, v132
  v_permlane16_swap_b32 v131, v133
  buffer_store_dwordx4 v[130:133], v10, s[32:35], s60 offen offset:0 nt
  s_waitcnt vmcnt(7)
  s_barrier
  ds_read_b128 v[66:69], v59 offset:0
  ds_read_b128 v[70:73], v59 offset:1024
  ds_read_b128 v[74:77], v59 offset:2048
  ds_read_b128 v[78:81], v59 offset:3072
  ds_read_b128 v[82:85], v59 offset:4096
  ds_read_b128 v[86:89], v59 offset:5120
  ds_read_b128 v[90:93], v59 offset:6144
  ds_read_b128 v[94:97], v59 offset:7168
  s_waitcnt vmcnt(0)
  s_cmp_lg_u32 s82, 0
  s_cbranch_scc1 L_far16
  buffer_store_dword v12, v2, s[32:35], s64 offen offset:896
L_near16:
  s_waitcnt lgkmcnt(7)
  v_mfma_f32_16x16x32_bf16 v[18:21], v[62:65], v[66:69], v[18:21]
  s_waitcnt lgkmcnt(6)
  v_mfma_f32_16x16x32_bf16 v[22:25], v[62:65], v[70:73], v[22:25]
  s_waitcnt lgkmcnt(5)
  v_mfma_f32_16x16x32_bf16 v[18:21], v[62:65], v[74:77], v[18:21]
  s_waitcnt lgkmcnt(4)
  v_mfma_f32_16x16x32_bf16 v[22:25], v[62:65], v[78:81], v[22:25]
  s_waitcnt lgkmcnt(3)
  v_mfma_f32_16x16x32_bf16 v[18:21], v[62:65], v[82:85], v[18:21]
  s_waitcnt lgkmcnt(2)
  v_mfma_f32_16x16x32_bf16 v[22:25], v[62:65], v[86:89], v[22:25]
  s_waitcnt lgkmcnt(1)
  v_mfma_f32_16x16x32_bf16 v[18:21], v[62:65], v[90:93], v[18:21]
  s_waitcnt lgkmcnt(0)
  v_mfma_f32_16x16x32_bf16 v[22:25], v[62:65], v[94:97], v[22:25]
  s_nop 5
  v_pk_fma_f32 v[18:19], v[18:19], s[82:83], v[26:27] op_sel:[0,1,0] op_sel_hi:[1,1,1]
  v_pk_fma_f32 v[20:21], v[20:21], s[82:83], v[28:29] op_sel:[0,1,0] op_sel_hi:[1,1,1]
  v_pk_fma_f32 v[22:23], v[22:23], s[82:83], v[30:31] op_sel:[0,1,0] op_sel_hi:[1,1,1]
  v_pk_fma_f32 v[24:25], v[24:25], s[82:83], v[32:33] op_sel:[0,1,0] op_sel_hi:[1,1,1]
  v_cvt_pk_bf16_f32 v50, v18, v19
  v_cvt_pk_bf16_f32 v52, v22, v23
  v_cvt_pk_bf16_f32 v51, v20, v21
  v_cvt_pk_bf16_f32 v53, v24, v25
  v_permlane16_swap_b32 v50, v52
  s_nop 0
  v_permlane16_swap_b32 v51, v53
  buffer_load_dword v126, v1, s[32:35], s76 offen offset:896 sc1
  buffer_store_dwordx4 v[50:53], v16, s[36:39], 0 offen offset:0 nt
  s_waitcnt vmcnt(1)
  v_cmp_ne_u32 vcc, s4, v126
  s_cbranch_vccnz L_spin17
L_done17:
  s_add_u32 s6, s74, 32768
  s_add_u32 s7, s74, 36864
  buffer_load_dwordx4 v[66:69], v11, s[32:35], s6 offen offset:0 sc1
  buffer_load_dwordx4 v[70:73], v11, s[32:35], s6 offen offset:1024 sc1
  buffer_load_dwordx4 v[74:77], v11, s[32:35], s6 offen offset:2048 sc1
  buffer_load_dwordx4 v[78:81], v11, s[32:35], s6 offen offset:3072 sc1
  buffer_load_dwordx4 v[82:85], v11, s[32:35], s7 offen offset:0 sc1
  buffer_load_dwordx4 v[86:89], v11, s[32:35], s7 offen offset:1024 sc1
  buffer_load_dwordx4 v[90:93], v11, s[32:35], s7 offen offset:2048 sc1
  buffer_load_dwordx4 v[94:97], v11, s[32:35], s7 offen offset:3072 sc1
  s_waitcnt vmcnt(7)
  v_mfma_f32_16x16x32_bf16 v[34:37], v[62:65], v[66:69], v[34:37]
  s_waitcnt vmcnt(6)
  v_mfma_f32_16x16x32_bf16 v[38:41], v[62:65], v[70:73], v[38:41]
  s_waitcnt vmcnt(5)
  v_mfma_f32_16x16x32_bf16 v[34:37], v[62:65], v[74:77], v[34:37]
  s_waitcnt vmcnt(4)
  v_mfma_f32_16x16x32_bf16 v[38:41], v[62:65], v[78:81], v[38:41]
  s_waitcnt vmcnt(3)
  v_mfma_f32_16x16x32_bf16 v[34:37], v[62:65], v[82:85], v[34:37]
  s_waitcnt vmcnt(2)
  v_mfma_f32_16x16x32_bf16 v[38:41], v[62:65], v[86:89], v[38:41]
  s_waitcnt vmcnt(1)
  v_mfma_f32_16x16x32_bf16 v[34:37], v[62:65], v[90:93], v[34:37]
  s_waitcnt vmcnt(0)
  v_mfma_f32_16x16x32_bf16 v[38:41], v[62:65], v[94:97], v[38:41]
  s_nop 5
  v_pk_fma_f32 v[34:35], v[34:35], s[82:83], v[26:27] op_sel:[0,1,0] op_sel_hi:[1,1,1]
  v_pk_fma_f32 v[36:37], v[36:37], s[82:83], v[28:29] op_sel:[0,1,0] op_sel_hi:[1,1,1]
  v_pk_fma_f32 v[38:39], v[38:39], s[82:83], v[30:31] op_sel:[0,1,0] op_sel_hi:[1,1,1]
  v_pk_fma_f32 v[40:41], v[40:41], s[82:83], v[32:33] op_sel:[0,1,0] op_sel_hi:[1,1,1]
  v_cvt_pk_bf16_f32 v54, v34, v35
  v_cvt_pk_bf16_f32 v56, v38, v39
  v_cvt_pk_bf16_f32 v55, v36, v37
  v_cvt_pk_bf16_f32 v57, v40, v41
  v_permlane16_swap_b32 v54, v56
  s_nop 0
  v_permlane16_swap_b32 v55, v57
  buffer_store_dwordx4 v[54:57], v16, s[36:39], 0 offen offset:896 nt
  s_endpgm
L_strip:
  s_cmp_lg_u32 s61, 0
  s_cbranch_scc1 L_stripdone
  s_mov_b32 s79, 48
L_stripnear:
  buffer_load_dword v94, v107, s[32:35], s60 offen sc1
  s_waitcnt vmcnt(0)
  v_cmp_ne_u32 vcc, v92, v94
  s_sub_u32 s79, s79, 1
  s_nop 1
  s_cbranch_vccz L_stripdone
  s_cbranch_scc0 L_stripnear
  buffer_wbl2 sc1
  s_bfe_u32 s5, s60, 0x30009
  s_lshl2_add_u32 s5, s5, s3
  s_lshl_b32 s5, s5, 5
  s_lshr_b32 s6, s2, 3
  s_add_u32 s5, s5, s6
  s_lshl2_add_u32 s5, s5, 4096
  v_mov_b32 v93, s4
  s_waitcnt vmcnt(0)
  buffer_store_dword v93, v2, s[32:35], s5 offen sc1
  s_and_b32 s5, s60, 4095
  s_add_u32 s5, s5, 4096
  s_mov_b32 s79, 20000
  s_waitcnt vmcnt(0)
L_stripfar:
  buffer_load_dword v94, v107, s[32:35], s60 offen sc1
  buffer_load_dword v93, v107, s[32:35], s5 offen sc1
  s_waitcnt vmcnt(0)
  v_xor_b32 v94, v92, v94
  v_xor_b32 v93, s4, v93
  v_min_u32 v94, v93, v94
  v_cmp_ne_u32 vcc, 0, v94
  s_sub_u32 s79, s79, 1
  s_nop 1
  s_cbranch_scc1 L_stripdone
  s_cbranch_vccnz L_stripfar
  s_branch L_stripdone
L_spin1:
  s_mov_b32 s79, 20000
L_again1:
  buffer_load_dword v90, v88, s[32:35], s78 offen sc1
  buffer_load_dword v91, v89, s[32:35], s78 offen sc1
  s_waitcnt vmcnt(0)
  v_xor_b32 v90, s4, v90
  v_xor_b32 v91, s4, v91
  v_or_b32 v90, v90, v91
  v_cmp_lt_u32 vcc, 15, v90
  s_sub_u32 s79, s79, 1
  s_nop 1
  s_cbranch_scc1 L_done1
  s_cbranch_vccnz L_again1
  s_branch L_done1
L_far2:
  buffer_wbl2 sc1
  s_waitcnt vmcnt(0)
  buffer_store_dword v134, v2, s[32:35], s64 offen offset:0 sc1
  s_branch L_near2
L_spin3:
  s_mov_b32 s79, 20000
L_again3:
  buffer_load_dword v135, v1, s[32:35], s76 offen offset:0 sc1
  s_waitcnt vmcnt(0)
  v_cmp_ne_u32 vcc, s4, v135
  s_sub_u32 s79, s79, 1
  s_nop 1
  s_cbranch_scc1 L_done3
  s_cbranch_vccnz L_again3
  s_branch L_done3
L_far4:
  buffer_wbl2 sc1
  s_waitcnt vmcnt(0)
  buffer_store_dword v12, v2, s[32:35], s64 offen offset:128 sc1
  s_branch L_near4
L_spin5:
  s_mov_b32 s79, 20000
L_again5:
  buffer_load_dword v127, v1, s[32:35], s76 offen offset:128 sc1
  s_waitcnt vmcnt(0)
  v_cmp_ne_u32 vcc, s4, v127
  s_sub_u32 s79, s79, 1
  s_nop 1
  s_cbranch_scc1 L_done5
  s_cbranch_vccnz L_again5
  s_branch L_done5
L_far6:
  buffer_wbl2 sc1
  s_waitcnt vmcnt(0)
  buffer_store_dword v12, v2, s[32:35], s64 offen offset:256 sc1
  s_branch L_near6
L_spin7:
  s_mov_b32 s79, 20000
L_again7:
  buffer_load_dword v18, v1, s[32:35], s76 offen offset:256 sc1
  s_waitcnt vmcnt(0)
  v_cmp_ne_u32 vcc, s4, v18
  s_sub_u32 s79, s79, 1
  s_nop 1
  s_cbranch_scc1 L_done7
  s_cbranch_vccnz L_again7
  s_branch L_done7
L_far8:
  buffer_wbl2 sc1
  s_waitcnt vmcnt(0)
  buffer_store_dword v12, v2, s[32:35], s64 offen offset:384 sc1
  s_branch L_near8
L_far9:
  buffer_wbl2 sc1
  s_waitcnt vmcnt(0)
  buffer_store_dword v12, v2, s[32:35], s64 offen offset:512 sc1
  s_branch L_near9
L_spin10:
  s_mov_b32 s79, 20000
L_again10:
  buffer_load_dword v126, v1, s[32:35], s76 offen offset:384 sc1
  s_waitcnt vmcnt(0)
  v_cmp_ne_u32 vcc, s4, v126
  s_sub_u32 s79, s79, 1
  s_nop 1
  s_cbranch_scc1 L_done10
  s_cbranch_vccnz L_again10
  s_branch L_done10
L_spin11:
  s_mov_b32 s79, 20000
L_again11:
  buffer_load_dword v127, v1, s[32:35], s76 offen offset:512 sc1
  s_waitcnt vmcnt(0)
  v_cmp_ne_u32 vcc, s4, v127
  s_sub_u32 s79, s79, 1
  s_nop 1
  s_cbranch_scc1 L_done11
  s_cbranch_vccnz L_again11
  s_branch L_done11
L_far12:
  buffer_wbl2 sc1
  s_waitcnt vmcnt(0)
  buffer_store_dword v12, v2, s[32:35], s64 offen offset:640 sc1
  s_branch L_near12
L_spin13:
  s_mov_b32 s79, 20000
L_again13:
  buffer_load_dword v127, v1, s[32:35], s76 offen offset:640 sc1
  s_waitcnt vmcnt(0)
  v_cmp_ne_u32 vcc, s4, v127
  s_sub_u32 s79, s79, 1
  s_nop 1
  s_cbranch_scc1 L_done13
  s_cbranch_vccnz L_again13
  s_branch L_done13
L_far14:
  buffer_wbl2 sc1
  s_waitcnt vmcnt(0)
  buffer_store_dword v12, v2, s[32:35], s64 offen offset:768 sc1
  s_branch L_near14
L_spin15:
  s_mov_b32 s79, 20000
L_again15:
  buffer_load_dword v18, v1, s[32:35], s76 offen offset:768 sc1
  s_waitcnt vmcnt(0)
  v_cmp_ne_u32 vcc, s4, v18
  s_sub_u32 s79, s79, 1
  s_nop 1
  s_cbranch_scc1 L_done15
  s_cbranch_vccnz L_again15
  s_branch L_done15
L_far16:
  buffer_wbl2 sc1
  s_waitcnt vmcnt(0)
  buffer_store_dword v12, v2, s[32:35], s64 offen offset:896 sc1
  s_branch L_near16
L_spin17:
  s_mov_b32 s79, 20000
L_again17:
  buffer_load_dword v126, v1, s[32:35], s76 offen offset:896 sc1
  s_waitcnt vmcnt(0)
  v_cmp_ne_u32 vcc, s4, v126
  s_sub_u32 s79, s79, 1
  s_nop 1
  s_cbranch_scc1 L_done17
  s_cbranch_vccnz L_again17
  s_branch L_done17
L_end:
  s_endpgm
.section .rodata,"a"
.p2align 6
.amdhsa_kernel interleave_layers__ssm_conv_h3__mixer_channel_mlp__prompt_kernel
  .amdhsa_next_free_vgpr 512
  .amdhsa_next_free_sgpr 102
  .amdhsa_accum_offset 256
  .amdhsa_group_segment_fixed_size 0
  .amdhsa_kernarg_size 112
  .amdhsa_user_sgpr_count 2
  .amdhsa_user_sgpr_kernarg_segment_ptr 1
  .amdhsa_system_sgpr_workgroup_id_x 1
.end_amdhsa_kernel
```
